```python
import torch

def _softmax(x, axis=-1):
    return torch.softmax(x, dim=axis)
def _gelu(x):
    return torch.nn.functional.gelu(x, approximate="tanh")
def _silu(x):
    return torch.nn.functional.silu(x)
def _sigmoid(x):
    return torch.sigmoid(x)
def _layernorm(x, axis=-1, eps=1e-5):
    m = x.mean(dim=axis, keepdim=True)
    v = x.var(dim=axis, keepdim=True, unbiased=False)
    return (x - m) / torch.sqrt(v + eps)
def _scatter_add(tgt, idx, src, axis=0):
    return tgt.clone().index_add_(axis, idx, src)
def _segment_sum(src, seg, n):
    out = torch.zeros((n,) + src.shape[1:], dtype=src.dtype)
    return out.index_add_(0, seg, src)
def _pad(x, pw):
    flat = tuple(v for pair in reversed(pw) for v in pair)
    return torch.nn.functional.pad(x, flat)

kernel_name = 'sequential_preLN__compressed_kv_cla__mixer_token_mlp__decode'

def setup_inputs():

    _w = (lambda a: (lambda t: t.to(torch.bfloat16) if t.is_floating_point() else t)(torch.as_tensor(a)))
    def _A_setup():
        B, H, Sq, Sk, D, M = 1, 32, 1, 4096, 128, 640
        Dc = 4 * D
        return {
            "x": _w((lambda *s: torch.randn(*s, dtype=torch.bfloat16) * 0.05)(B, Sq, M)),
            "c_kv": _w((lambda *s: torch.randn(*s, dtype=torch.bfloat16) * 0.8)(B, Sk, Dc)),
            "w_q": _w((lambda *s: torch.randn(*s, dtype=torch.bfloat16) * 0.8)(M, H, D) * (M ** -0.5)),
            "w_uk": _w((lambda *s: torch.randn(*s, dtype=torch.bfloat16) * 0.8)(Dc, H, D) * (Dc ** -0.5)),
            "w_uv": _w((lambda *s: torch.randn(*s, dtype=torch.bfloat16) * 0.8)(Dc, H, D) * (Dc ** -0.5)),
            "w_o": _w((lambda *s: torch.randn(*s, dtype=torch.bfloat16) * 0.8)(H, D, M) * ((H * D) ** -0.5)),
        }
    _A_in = _A_setup()

    def _B_setup():
        B, S, D, F = 1, 1, 640, 1728
        return {
            "x": _w((lambda *s: torch.randn(*s, dtype=torch.bfloat16) * 0.05)(B, S, D)),
            "w1": _w((lambda *s: torch.randn(*s, dtype=torch.bfloat16) * 0.2)(S, F) * (S ** -0.5)),
            "b1": _w((lambda *s: torch.randn(*s, dtype=torch.bfloat16) * 0.2)(F) * 0.02),
            "w2": _w((lambda *s: torch.randn(*s, dtype=torch.bfloat16) * 0.2)(F, S) * (F ** -0.5)),
            "b2": _w((lambda *s: torch.randn(*s, dtype=torch.bfloat16) * 0.2)(S) * 0.02),
        }
    _B_in = _B_setup()

    return {
        "A_x": _A_in["x"],
        "A_c_kv": _A_in["c_kv"],
        "A_w_q": _A_in["w_q"],
        "A_w_uk": _A_in["w_uk"],
        "A_w_uv": _A_in["w_uv"],
        "A_w_o": _A_in["w_o"],
        "B_x": _B_in["x"],
        "B_w1": _B_in["w1"],
        "B_b1": _B_in["b1"],
        "B_w2": _B_in["w2"],
        "B_b2": _B_in["b2"],
    }

def reference(A_x, A_c_kv, A_w_q, A_w_uk, A_w_uv, A_w_o, B_x, B_w1, B_b1, B_w2, B_b2):
    def _A_ref(x, c_kv, w_q, w_uk, w_uv, w_o):
        B, Sq, M = x.shape[0], x.shape[1], x.shape[2]
        Sk = c_kv.shape[1]
        H, D = w_q.shape[1], w_q.shape[2]
        q = torch.einsum("bqm,mhd->bhqd", x, w_q)
        k = torch.einsum("bkc,chd->bhkd", c_kv, w_uk)
        v = torch.einsum("bkc,chd->bhkd", c_kv, w_uv)
        scores = torch.einsum("bhqd,bhkd->bhqk", q, k) * (D ** -0.5)
        off = Sk - Sq
        qi = torch.arange(Sq)[:, None]
        kj = torch.arange(Sk)[None, :]
        cmask = kj <= (qi + off)
        scores = torch.where(cmask[None, None], scores, -1e9)
        p = _softmax(scores, axis=-1)
        ctx = torch.einsum("bhqk,bhkd->bhqd", p, v)
        return torch.einsum("bhqd,hdm->bqm", ctx, w_o)

    def _B_ref(x, w1, b1, w2, b2):
        B, S, D = x.shape
        h = _layernorm(x, axis=-1)
        u = torch.einsum("bsd,sf->bdf", h, w1) + b1
        u = _gelu(u)
        y = torch.einsum("bdf,fs->bds", u, w2) + b2
        return (lambda x, *d: x.permute(*d))(y, 0, 2, 1)

    x = A_x
    h = x + _A_ref(_layernorm(x, axis=-1), A_c_kv, A_w_q, A_w_uk, A_w_uv, A_w_o)
    h2 = h + _B_ref(_layernorm(h, axis=-1), B_w1, B_b1, B_w2, B_b2)
    return h2
```

```asm
; @launch grid=(256,1,1) block=(512,1,1) lds=152384
.amdgcn_target "amdgcn-amd-amdhsa--gfx950"
.text
.globl sequential_preLN__compressed_kv_cla__mixer_token_mlp__decode_kernel
.p2align 8
.type sequential_preLN__compressed_kv_cla__mixer_token_mlp__decode_kernel,@function
sequential_preLN__compressed_kv_cla__mixer_token_mlp__decode_kernel:
    s_cmp_ge_u32 s2, 256
    s_cbranch_scc1 L_exit
    s_load_dwordx16 s[8:23], s[0:1], 0
    s_load_dwordx4 s[32:35], s[0:1], 96
    s_load_dwordx8 s[24:31], s[0:1], 64

    s_cmp_lt_u32 s2, 16
    s_cbranch_scc0 L_nopf
    s_getpc_b64 s[64:65]

L_pc:
    s_and_b32 s64, s64, 0xffffff00
    v_lshlrev_b32 v203, 7, v0
    v_min_u32 v203, L_end-L_pc-4, v203
    v_mov_b32 v201, s65
    v_add_co_u32 v200, vcc, s64, v203
    s_nop 1
    v_addc_co_u32 v201, vcc, 0, v201, vcc
    global_load_dword v202, v[200:201], off

L_nopf:
    v_and_b32 v1, 63, v0
    v_lshrrev_b32 v4, 6, v0
    v_lshrrev_b32 v2, 4, v1
    v_readfirstlane_b32 s4, v4
    v_and_b32 v3, 15, v1
    s_and_b32 s5, s2, 7
    s_bfe_u32 s6, s2, 0x40003
    s_lshr_b32 s37, s6, 2
    s_xor_b32 s37, s37, 0
    s_lshl_b32 s3, s5, 2
    s_add_u32 s37, s37, s3
    s_and_b32 s38, s6, 3
    s_mov_b32 s43, 0x20000
    s_mov_b32 s100, 131072
    s_cmp_ge_u32 s2, 128
    s_cbranch_scc1 L_B0

    s_lshl_b32 s66, s4, 2
    s_and_b32 s66, s66, 8
    s_mul_i32 s64, s38, 40
    s_add_u32 s64, s64, s4
    s_lshl_b32 s64, s64, 15
    s_lshl_b32 s65, s37, 8
    s_add_u32 s64, s64, s65
    s_lshl_b32 s67, s4, 10
    s_add_u32 s67, s67, 32768
    s_mov_b32 s42, 5242880
    v_lshlrev_b32 v7, 1, v2
    v_xor_b32 v7, v7, v3
    v_xor_b32 v7, s66, v7
    v_lshlrev_b32 v7, 4, v7
    v_lshl_add_u32 v7, v2, 13, v7
    v_lshlrev_b32 v6, 2, v1
    s_cmp_eq_u32 s4, 0
    s_waitcnt lgkmcnt(0)
    s_mov_b32 s40, s12
    s_mov_b32 s41, s13
    s_cbranch_scc0 L_f_nox

    global_load_dword v8, v6, s[8:9] offset:0
    global_load_dword v9, v6, s[8:9] offset:256
    global_load_dword v10, v6, s[8:9] offset:512
    global_load_dword v11, v6, s[8:9] offset:768
    global_load_dword v12, v6, s[8:9] offset:1024
L_f_nox:
    s_mov_b32 m0, s67
    s_add_u32 s67, s67, 8192
    buffer_load_dwordx4 v7, s[40:43], s64 offen nt lds
    s_add_u32 s64, s64, 262144

    s_mov_b32 m0, s67
    s_add_u32 s67, s67, 8192
    buffer_load_dwordx4 v7, s[40:43], s64 offen nt lds
    s_add_u32 s64, s64, 262144

    s_mov_b32 m0, s67
    s_add_u32 s67, s67, 8192
    buffer_load_dwordx4 v7, s[40:43], s64 offen nt lds
    s_add_u32 s64, s64, 262144

    s_mov_b32 m0, s67
    s_add_u32 s67, s67, 8192
    buffer_load_dwordx4 v7, s[40:43], s64 offen nt lds
    s_add_u32 s64, s64, 262144

    s_mov_b32 m0, s67
    s_add_u32 s67, s67, 8192
    buffer_load_dwordx4 v7, s[40:43], s64 offen nt lds
    s_add_u32 s64, s64, 262144

    s_load_dword s36, s[34:35], 0
    s_branch L_F1

L_B0:
    s_lshl_b32 s3, s4, 1
    v_xor_b32 v7, s3, v1
    v_lshlrev_b32 v7, 4, v7
    s_lshl_b32 s39, s5, 2
    s_add_u32 s39, s39, s38
    s_lshl_b32 s66, s39, 17
    s_and_b32 s67, s6, 12
    s_lshl_b32 s67, s67, 13
    s_lshl_b32 s65, s4, 10
    s_add_u32 s67, s67, s65
    s_mov_b32 s42, 4194304
    s_mov_b32 s68, 15
    v_bfe_u32 v4, v1, 1, 4
    s_lshl_b32 s3, s38, 7
    s_lshl_b32 s64, s4, 4
    s_add_u32 s3, s3, s64
    v_add_u32 v4, s3, v4
    v_lshlrev_b32 v4, 13, v4
    v_and_b32 v5, 1, v1
    v_lshl_add_u32 v4, v5, 7, v4
    s_lshl_b32 s3, s37, 8
    v_add_u32 v4, s3, v4
    s_waitcnt lgkmcnt(0)
    s_mov_b32 s40, s10
    s_mov_b32 s41, s11

    s_sleep 14
L_b_dma:
    s_mov_b32 m0, s67
    s_add_u32 s69, s67, s66
    buffer_load_dwordx4 v7, s[40:43], s69 offen lds
    s_add_u32 s67, s67, 8192
    s_and_b32 s67, s67, 0x1ffff
    s_sub_u32 s68, s68, 1
    s_cbranch_scc0 L_b_dma

    s_load_dword s36, s[34:35], 0
    s_branch L_B1
L_F1:
    s_mov_b32 s7, 0
    v_bfe_u32 v62, v1, 2, 2
    v_bfe_u32 v63, v1, 1, 1
    v_and_b32 v59, 1, v1
    v_lshlrev_b32 v59, 3, v59

    v_and_b32 v41, 1, v2
    v_lshl_add_u32 v41, v41, 2, v62
    v_lshlrev_b32 v41, 1, v41
    s_and_b32 s65, s4, 3
    s_lshl_b32 s3, s65, 2
    v_add_u32 v42, s3, v63
    v_xor_b32 v41, v41, v42
    v_lshl_add_u32 v41, v41, 4, v59
    v_lshl_add_u32 v42, v2, 3, v62
    v_lshl_add_u32 v41, v42, 8, v41
    v_add_u32 v41, 32768, v41
    v_xor_b32 v40, 32, v41
    s_mul_i32 s3, s38, 320
    s_add_u32 s3, s3, 143872
    v_lshl_add_u32 v42, v2, 4, s3
    s_lshl_b32 s3, s37, 2
    s_add_u32 s3, s3, s38
    s_lshl_b32 s3, s3, 9
    s_lshl_b32 s64, s65, 7
    s_add_u32 s3, s3, s64
    s_add_u32 s65, s3, 65536
    v_and_b32 v43, 1, v1
    v_lshlrev_b32 v43, 6, v43
    v_lshl_add_u32 v43, v2, 4, v43
    v_add_u32 v43, s65, v43
    v_add_u32 v44, 65536, v43
    s_lshl_b32 s64, s4, 6
    s_lshl_b32 s3, s37, 2
    s_and_b32 s65, s4, 3
    s_add_u32 s3, s3, s65
    s_lshl_b32 s3, s3, 9
    s_add_u32 s3, s3, 65536
    v_lshl_add_u32 v45, v1, 3, s3
    v_add_u32 v49, 65536, v45
    s_mul_i32 s3, s65, 288
    s_add_u32 s3, s3, 145152
    v_lshl_add_u32 v46, v1, 2, s3
    v_bfe_u32 v47, v3, 1, 2
    v_mul_u32_u24 v47, 288, v47
    v_lshl_add_u32 v47, v2, 4, v47
    v_add_u32 v47, 145152, v47
    s_and_b32 s66, s4, 3
    s_lshl_b32 s3, s37, 10
    s_lshl_b32 s65, s38, 8
    s_add_u32 s3, s3, s65
    s_lshl_b32 s64, s66, 6
    s_add_u32 s3, s3, s64
    s_add_u32 s65, s3, 327680
    v_and_b32 v50, 1, v1
    v_lshlrev_b32 v50, 1, v50
    v_lshrrev_b32 v51, 1, v2
    v_add_u32 v50, v50, v51
    v_lshl_add_u32 v48, v50, 4, s65
    s_lshl_b32 s3, s66, 5
    v_add_u32 v24, s3, v3
    v_lshlrev_b32 v24, 8, v24
    v_and_b32 v25, 7, v3
    v_lshlrev_b32 v25, 1, v25
    v_xor_b32 v25, v25, v2
    v_lshl_add_u32 v24, v25, 4, v24
    v_add_u32 v24, 73728, v24
    v_xor_b32 v25, 64, v24
    v_xor_b32 v26, 128, v24
    v_xor_b32 v27, 192, v24
    s_waitcnt lgkmcnt(0)

    s_mul_i32 s36, s36, 1664525
    s_add_u32 s36, s36, 1013904223
    v_mov_b32 v105, s36
    v_mov_b32 v107, s36
    v_lshlrev_b32 v56, 3, v50
    v_mov_b32 v57, s36
    v_lshrrev_b32 v56, v56, v57
    v_bfe_u32 v52, v56, 0, 1
    v_bfe_u32 v57, v56, 1, 1
    v_lshl_or_b32 v52, v57, 16, v52
    v_bfe_u32 v53, v56, 2, 1
    v_bfe_u32 v57, v56, 3, 1
    v_lshl_or_b32 v53, v57, 16, v53
    v_bfe_u32 v54, v56, 4, 1
    v_bfe_u32 v57, v56, 5, 1
    v_lshl_or_b32 v54, v57, 16, v54
    v_bfe_u32 v55, v56, 6, 1
    v_bfe_u32 v57, v56, 7, 1
    v_lshl_or_b32 v55, v57, 16, v55
    s_cmp_eq_u32 s4, 0
    s_cbranch_scc0 L_f_noln

    s_waitcnt vmcnt(5)
    v_lshlrev_b32 v64, 16, v8
    v_and_b32 v65, 0xffff0000, v8
    v_lshlrev_b32 v66, 16, v9
    v_and_b32 v67, 0xffff0000, v9
    v_lshlrev_b32 v68, 16, v10
    v_and_b32 v69, 0xffff0000, v10
    v_lshlrev_b32 v70, 16, v11
    v_and_b32 v71, 0xffff0000, v11
    v_lshlrev_b32 v72, 16, v12
    v_and_b32 v73, 0xffff0000, v12
    v_pk_add_f32 v[74:75], v[64:65], v[66:67]
    v_pk_add_f32 v[76:77], v[68:69], v[70:71]
    v_pk_add_f32 v[74:75], v[74:75], v[72:73]
    v_pk_add_f32 v[74:75], v[74:75], v[76:77]
    v_mov_b32 v78, 0xbacccccd
    v_add_f32 v74, v74, v75

    s_nop 1
    v_add_f32_dpp v74, v74, v74 row_shr:1 row_mask:0xf bank_mask:0xf bound_ctrl:0
    s_nop 1
    v_add_f32_dpp v74, v74, v74 row_shr:2 row_mask:0xf bank_mask:0xf bound_ctrl:0
    s_nop 1
    v_add_f32_dpp v74, v74, v74 row_shr:4 row_mask:0xf bank_mask:0xf bound_ctrl:0
    s_nop 1
    v_add_f32_dpp v74, v74, v74 row_shr:8 row_mask:0xf bank_mask:0xf bound_ctrl:0
    s_nop 1
    v_add_f32_dpp v74, v74, v74 row_bcast:15 row_mask:0xa bank_mask:0xf
    s_nop 1
    v_add_f32_dpp v74, v74, v74 row_bcast:31 row_mask:0xc bank_mask:0xf
    s_nop 0
    v_readlane_b32 s20, v74, 63
    v_mov_b32 v80, 0x3acccccd
    v_mov_b32 v81, 0x3727c5ac
    v_mul_f32 v78, s20, v78
    v_pk_add_f32 v[64:65], v[64:65], v[78:79] op_sel_hi:[1,0]
    v_pk_add_f32 v[66:67], v[66:67], v[78:79] op_sel_hi:[1,0]
    v_pk_add_f32 v[68:69], v[68:69], v[78:79] op_sel_hi:[1,0]
    v_pk_add_f32 v[70:71], v[70:71], v[78:79] op_sel_hi:[1,0]
    v_pk_add_f32 v[72:73], v[72:73], v[78:79] op_sel_hi:[1,0]
    v_pk_mul_f32 v[74:75], v[64:65], v[64:65]
    v_pk_fma_f32 v[74:75], v[66:67], v[66:67], v[74:75]
    v_pk_fma_f32 v[74:75], v[68:69], v[68:69], v[74:75]
    v_pk_fma_f32 v[74:75], v[70:71], v[70:71], v[74:75]
    v_pk_fma_f32 v[74:75], v[72:73], v[72:73], v[74:75]
    v_add_f32 v74, v74, v75
    s_nop 1
    v_add_f32_dpp v74, v74, v74 row_shr:1 row_mask:0xf bank_mask:0xf bound_ctrl:0
    s_nop 1
    v_add_f32_dpp v74, v74, v74 row_shr:2 row_mask:0xf bank_mask:0xf bound_ctrl:0
    s_nop 1
    v_add_f32_dpp v74, v74, v74 row_shr:4 row_mask:0xf bank_mask:0xf bound_ctrl:0
    s_nop 1
    v_add_f32_dpp v74, v74, v74 row_shr:8 row_mask:0xf bank_mask:0xf bound_ctrl:0
    s_nop 1
    v_add_f32_dpp v74, v74, v74 row_bcast:15 row_mask:0xa bank_mask:0xf
    s_nop 1
    v_add_f32_dpp v74, v74, v74 row_bcast:31 row_mask:0xc bank_mask:0xf
    s_nop 0
    v_readlane_b32 s21, v74, 63
    v_mov_b32 v82, 0x3e02f21f
    v_add_u32 v6, 143872, v6
    v_fma_f32 v74, s21, v80, v81
    v_rsq_f32 v74, v74
    s_nop 0
    v_mul_f32 v74, v74, v82
    v_pk_mul_f32 v[64:65], v[64:65], v[74:75] op_sel_hi:[1,0]
    v_pk_mul_f32 v[66:67], v[66:67], v[74:75] op_sel_hi:[1,0]
    v_pk_mul_f32 v[68:69], v[68:69], v[74:75] op_sel_hi:[1,0]
    v_pk_mul_f32 v[70:71], v[70:71], v[74:75] op_sel_hi:[1,0]
    v_pk_mul_f32 v[72:73], v[72:73], v[74:75] op_sel_hi:[1,0]
    v_cvt_pk_bf16_f32 v8, v64, v65
    ds_write_b32 v6, v8 offset:0
    v_cvt_pk_bf16_f32 v9, v66, v67
    ds_write_b32 v6, v9 offset:256
    v_cvt_pk_bf16_f32 v10, v68, v69
    ds_write_b32 v6, v10 offset:512
    v_cvt_pk_bf16_f32 v11, v70, v71
    ds_write_b32 v6, v11 offset:768
    v_cvt_pk_bf16_f32 v12, v72, v73
    ds_write_b32 v6, v12 offset:1024
L_f_noln:
    s_waitcnt vmcnt(0) lgkmcnt(0)
    s_barrier
    s_cmp_lt_u32 s4, 4
    s_cbranch_scc1 L_f_uk
    ds_read_b128 v[84:87], v42 offset:0
    ds_read_b64_tr_b16 v[64:65], v41 offset:0
    ds_read_b64_tr_b16 v[66:67], v41 offset:1024
    ds_read_b64_tr_b16 v[112:113], v40 offset:0
    ds_read_b64_tr_b16 v[114:115], v40 offset:1024
    ds_read_b128 v[88:91], v42 offset:64
    ds_read_b64_tr_b16 v[68:69], v41 offset:8192
    ds_read_b64_tr_b16 v[70:71], v41 offset:9216
    ds_read_b64_tr_b16 v[116:117], v40 offset:8192
    ds_read_b64_tr_b16 v[118:119], v40 offset:9216
    ds_read_b128 v[92:95], v42 offset:128
    ds_read_b64_tr_b16 v[72:73], v41 offset:16384
    ds_read_b64_tr_b16 v[74:75], v41 offset:17408
    ds_read_b64_tr_b16 v[120:121], v40 offset:16384
    ds_read_b64_tr_b16 v[122:123], v40 offset:17408
    ds_read_b128 v[96:99], v42 offset:192
    ds_read_b64_tr_b16 v[76:77], v41 offset:24576
    ds_read_b64_tr_b16 v[78:79], v41 offset:25600
    ds_read_b64_tr_b16 v[124:125], v40 offset:24576
    ds_read_b64_tr_b16 v[126:127], v40 offset:25600
    ds_read_b128 v[100:103], v42 offset:256
    ds_read_b64_tr_b16 v[80:81], v41 offset:32768
    ds_read_b64_tr_b16 v[82:83], v41 offset:33792
    ds_read_b64_tr_b16 v[128:129], v40 offset:32768
    ds_read_b64_tr_b16 v[130:131], v40 offset:33792
    s_mov_b32 s64, 0xaaaaaaaa
    s_mov_b32 s65, 0xaaaaaaaa
    s_waitcnt lgkmcnt(15)
    v_mfma_f32_16x16x32_bf16 v[108:111], v[64:67], v[84:87], 0
    v_mfma_f32_16x16x32_bf16 v[132:135], v[112:115], v[84:87], 0
    s_waitcnt lgkmcnt(15)
    v_mfma_f32_16x16x32_bf16 v[108:111], v[68:71], v[88:91], v[108:111]
    v_mfma_f32_16x16x32_bf16 v[132:135], v[116:119], v[88:91], v[132:135]
    s_waitcnt lgkmcnt(10)
    v_mfma_f32_16x16x32_bf16 v[108:111], v[72:75], v[92:95], v[108:111]
    v_mfma_f32_16x16x32_bf16 v[132:135], v[120:123], v[92:95], v[132:135]
    s_waitcnt lgkmcnt(5)
    v_mfma_f32_16x16x32_bf16 v[108:111], v[76:79], v[96:99], v[108:111]
    v_mfma_f32_16x16x32_bf16 v[132:135], v[124:127], v[96:99], v[132:135]
    s_waitcnt lgkmcnt(0)
    v_mfma_f32_16x16x32_bf16 v[108:111], v[80:83], v[100:103], v[108:111]
    v_mfma_f32_16x16x32_bf16 v[132:135], v[128:131], v[100:103], v[132:135]
    s_mov_b32 exec_lo, 0x00030003
    s_mov_b32 exec_hi, 0x00030003
    s_nop 5
    v_cndmask_b32 v108, v108, v132, s[64:65]
    v_cndmask_b32 v109, v109, v133, s[64:65]
    v_cndmask_b32 v110, v110, v134, s[64:65]
    v_cndmask_b32 v111, v111, v135, s[64:65]
    v_cvt_pk_bf16_f32 v104, v108, v109
    v_cvt_pk_bf16_f32 v106, v110, v111

    global_store_dwordx4 v44, v[104:107], s[34:35]
    global_store_dwordx4 v43, v[104:107], s[34:35] sc1
    s_mov_b64 exec, -1
    s_barrier
    s_branch L_h1_bar
L_f_uk:
    s_mov_b32 s44, s14
    s_mov_b32 s45, s15
    s_mov_b32 s46, 4194304
    s_mov_b32 s47, 0x20000
    s_and_b32 s66, s4, 1
    s_lshl_b32 s66, s66, 3
    v_lshlrev_b32 v7, 1, v2
    v_xor_b32 v7, v7, v3
    v_xor_b32 v7, s66, v7
    v_lshlrev_b32 v7, 4, v7
    v_lshl_add_u32 v7, v2, 13, v7
    s_lshl_b32 s64, s38, 5
    s_add_u32 s64, s64, s4
    s_lshl_b32 s64, s64, 15
    s_lshl_b32 s65, s37, 8
    s_add_u32 s64, s64, s65
    s_lshl_b32 s67, s4, 10
    s_add_u32 s67, s67, 73728

    s_barrier
    s_mov_b32 m0, s67
    s_add_u32 s67, s67, 4096
    buffer_load_dwordx4 v7, s[44:47], s64 offen nt lds
    s_add_u32 s64, s64, 131072

    s_mov_b32 m0, s67
    s_add_u32 s67, s67, 4096
    buffer_load_dwordx4 v7, s[44:47], s64 offen nt lds
    s_add_u32 s64, s64, 131072

    s_mov_b32 m0, s67
    s_add_u32 s67, s67, 4096
    buffer_load_dwordx4 v7, s[44:47], s64 offen nt lds
    s_add_u32 s64, s64, 131072

    s_mov_b32 m0, s67
    s_add_u32 s67, s67, 4096
    buffer_load_dwordx4 v7, s[44:47], s64 offen nt lds
    s_add_u32 s64, s64, 131072

    s_mov_b32 m0, s67
    s_add_u32 s67, s67, 4096
    buffer_load_dwordx4 v7, s[44:47], s64 offen nt lds
    s_add_u32 s64, s64, 131072

    s_mov_b32 m0, s67
    s_add_u32 s67, s67, 4096
    buffer_load_dwordx4 v7, s[44:47], s64 offen nt lds
    s_add_u32 s64, s64, 131072

    s_mov_b32 m0, s67
    s_add_u32 s67, s67, 4096
    buffer_load_dwordx4 v7, s[44:47], s64 offen nt lds
    s_add_u32 s64, s64, 131072

    s_mov_b32 m0, s67
    s_add_u32 s67, s67, 4096
    buffer_load_dwordx4 v7, s[44:47], s64 offen nt lds
    s_add_u32 s64, s64, 131072

    s_mov_b32 s20, 10
L_h1:
    global_load_dwordx2 v[64:65], v49, s[34:35] sc1
    s_waitcnt vmcnt(0)
    v_cmp_ne_u32 vcc, s36, v65
    s_cbranch_vccz L_h1_done
    s_sub_u32 s100, s100, 1
    s_cbranch_scc1 L_fail
    s_sub_u32 s20, s20, 1
    s_cbranch_scc0 L_h1
    v_mov_b32 v49, v45
    s_mov_b32 s20, 0x7fffffff
    s_branch L_h1
L_h1_done:
    ds_write_b32 v46, v64
L_h1_bar:
    s_waitcnt lgkmcnt(0)
    s_barrier
    s_cmp_lt_u32 s4, 4
    s_cbranch_scc1 L_f_nos2
    ds_read_b128 v[64:67], v47 offset:0
    ds_read_b128 v[80:83], v24
    ds_read_b128 v[112:115], v24 offset:4096
    ds_read_b128 v[68:71], v47 offset:64
    ds_read_b128 v[84:87], v25
    ds_read_b128 v[116:119], v25 offset:4096
    ds_read_b128 v[72:75], v47 offset:128
    ds_read_b128 v[88:91], v26
    ds_read_b128 v[120:123], v26 offset:4096
    ds_read_b128 v[76:79], v47 offset:192
    ds_read_b128 v[92:95], v27
    ds_read_b128 v[124:127], v27 offset:4096
    s_mov_b32 s64, 0xaaaaaaaa
    s_mov_b32 s65, 0xaaaaaaaa
    s_waitcnt lgkmcnt(9)
    v_mfma_f32_16x16x32_bf16 v[108:111], v[80:83], v[64:67], 0
    v_mfma_f32_16x16x32_bf16 v[132:135], v[112:115], v[64:67], 0
    s_waitcnt lgkmcnt(6)
    v_mfma_f32_16x16x32_bf16 v[108:111], v[84:87], v[68:71], v[108:111]
    v_mfma_f32_16x16x32_bf16 v[132:135], v[116:119], v[68:71], v[132:135]
    s_waitcnt lgkmcnt(3)
    v_mfma_f32_16x16x32_bf16 v[108:111], v[88:91], v[72:75], v[108:111]
    v_mfma_f32_16x16x32_bf16 v[132:135], v[120:123], v[72:75], v[132:135]
    s_waitcnt lgkmcnt(0)
    v_mfma_f32_16x16x32_bf16 v[108:111], v[92:95], v[76:79], v[108:111]
    v_mfma_f32_16x16x32_bf16 v[132:135], v[124:127], v[76:79], v[132:135]
    s_nop 7
    v_cndmask_b32 v108, v108, v132, s[64:65]
    v_cndmask_b32 v109, v109, v133, s[64:65]
    v_cndmask_b32 v110, v110, v134, s[64:65]
    v_cndmask_b32 v111, v111, v135, s[64:65]
    v_add_f32_dpp v108, v108, v108 row_ror:2 row_mask:0xf bank_mask:0xf
    v_add_f32_dpp v109, v109, v109 row_ror:2 row_mask:0xf bank_mask:0xf
    v_add_f32_dpp v110, v110, v110 row_ror:2 row_mask:0xf bank_mask:0xf
    v_add_f32_dpp v111, v111, v111 row_ror:2 row_mask:0xf bank_mask:0xf
    v_add_f32_dpp v108, v108, v108 row_ror:4 row_mask:0xf bank_mask:0xf
    v_add_f32_dpp v109, v109, v109 row_ror:4 row_mask:0xf bank_mask:0xf
    v_add_f32_dpp v110, v110, v110 row_ror:4 row_mask:0xf bank_mask:0xf
    v_add_f32_dpp v111, v111, v111 row_ror:4 row_mask:0xf bank_mask:0xf
    v_cvt_pk_bf16_f32 v104, v108, v109
    v_cvt_pk_bf16_f32 v105, v110, v111
    s_mov_b32 s66, 0xfffefffe
    v_mov_b32 v106, v104
    v_mov_b32 v107, v105
    s_nop 1
    v_permlane16_swap_b32 v104, v106
    v_permlane16_swap_b32 v105, v107
    s_mov_b32 exec_lo, 3
    s_mov_b32 exec_hi, 3
    v_and_or_b32 v104, v104, s66, v52
    v_and_or_b32 v105, v105, s66, v53
    v_and_or_b32 v106, v106, s66, v54
    v_and_or_b32 v107, v107, s66, v55

    global_store_dwordx4 v48, v[104:107], s[34:35] sc1
    s_mov_b64 exec, -1
L_f_nos2:
    s_barrier
    v_lshrrev_b32 v4, 1, v1
    s_lshl_b32 s3, s38, 7
    s_lshl_b32 s64, s4, 4
    s_add_u32 s3, s3, s64
    v_and_b32 v4, 15, v4
    v_add_u32 v4, s3, v4
    v_lshlrev_b32 v4, 13, v4
    v_and_b32 v5, 1, v1
    v_lshl_add_u32 v4, v5, 7, v4
    s_lshl_b32 s3, s37, 8
    v_add_u32 v4, s3, v4
    s_mov_b64 exec, 0xffffffff
    global_load_dword v5, v4, s[16:17] nt
    s_mov_b64 exec, -1

    s_cmp_lt_u32 s6, 10
    s_cbranch_scc1 L_s6
    s_mov_b32 s52, s22
    s_mov_b32 s53, s23
    s_mov_b32 s54, 3456
    s_mov_b32 s55, 0x20000
    s_mov_b32 s56, s24
    s_mov_b32 s57, s25
    s_mov_b32 s58, 3456
    s_mov_b32 s59, 0x20000
    s_mov_b32 s60, s26
    s_mov_b32 s61, s27
    s_mov_b32 s62, 3456
    s_mov_b32 s63, 0x20000
    s_lshl_b32 s3, s4, 8
    v_lshl_add_u32 v4, v1, 2, s3
    buffer_load_dword v224, v4, s[52:55], 0 offen
    buffer_load_dword v225, v4, s[52:55], 0 offen offset:2048
    buffer_load_dword v226, v4, s[56:59], 0 offen
    buffer_load_dword v227, v4, s[56:59], 0 offen offset:2048
    buffer_load_dword v228, v4, s[60:63], 0 offen
    buffer_load_dword v229, v4, s[60:63], 0 offen offset:2048
    v_mov_b32 v4, 0
    global_load_ushort v231, v4, s[28:29]

    s_min_u32 s3, s4, 4
    s_lshl_b32 s3, s3, 8
    v_lshlrev_b32 v4, 4, v3
    v_and_b32 v230, 1, v2
    v_lshl_add_u32 v4, v230, 3, v4
    v_lshrrev_b32 v230, 1, v2
    v_lshl_add_u32 v4, v230, 2, v4
    v_add_u32 v4, s3, v4
    global_load_dword v230, v4, s[8:9]

    s_waitcnt vmcnt(0)
    v_lshlrev_b32 v232, 16, v224
    v_and_b32 v233, 0xffff0000, v224
    v_lshlrev_b32 v234, 16, v225
    v_and_b32 v235, 0xffff0000, v225
    v_lshlrev_b32 v236, 16, v226
    v_and_b32 v237, 0xffff0000, v226
    v_lshlrev_b32 v238, 16, v227
    v_and_b32 v239, 0xffff0000, v227
    v_lshlrev_b32 v240, 16, v228
    v_and_b32 v241, 0xffff0000, v228
    v_lshlrev_b32 v242, 16, v229
    v_and_b32 v243, 0xffff0000, v229
    v_mul_u32_u24 v244, 1280, v2
    v_lshl_add_u32 v244, v3, 4, v244
    s_lshl_b32 s3, s4, 8
    s_add_u32 s64, s3, 458752
    v_add_u32 v244, s64, v244
    v_add_u32 v245, 5120, v244
    s_lshl_b32 s3, s4, 9
    s_add_u32 s3, s3, 149632
    v_lshlrev_b32 v248, 5, v3
    v_and_b32 v57, 1, v2
    v_lshl_add_u32 v248, v57, 4, v248
    v_lshrrev_b32 v57, 1, v2
    v_lshl_add_u32 v248, v57, 3, v248
    v_add_u32 v248, s3, v248
    v_lshlrev_b32 v58, 16, v230
    v_and_b32 v59, 0xffff0000, v230
    v_mov_b32 v60, 0x3acccccd
    v_mov_b32 v61, 0x3f800054
    v_mov_b32 v65, 0x2edbe6ff
    v_mov_b32 v64, 0xc0135761
    v_mov_b32 v66, 0xbdd2d3e8
    v_mov_b32 v62, 152192
    s_lshr_b32 s101, s2, 3
    s_mul_i32 s101, s101, 3
    s_mul_i32 s3, s5, 80
    s_add_u32 s101, s101, s3
    s_lshl_b32 s3, s101, 2
    s_add_u32 s3, s3, 149632
    v_mov_b32 v63, s3
    s_lshl_b32 s3, s4, 3
    s_add_u32 s3, s3, 152192
    v_mov_b32 v68, s3
    s_lshl_b32 s3, s4, 4
    s_add_u32 s3, s3, 152256
    v_mov_b32 v69, s3
    v_mov_b32 v113, 0
    v_add_u32 v8, s101, v1
    v_lshlrev_b32 v6, 2, v1
    v_add_u32 v6, 152256, v6
    v_lshlrev_b32 v7, 2, v8
    v_add_u32 v7, 149632, v7
    v_lshlrev_b32 v9, 16, v231

    v_and_b32 v57, 3, v1
    v_lshlrev_b32 v14, 3, v57
    v_mov_b32 v15, s36
    v_lshrrev_b32 v14, v14, v15
    v_bfe_u32 v10, v14, 0, 1
    v_bfe_u32 v15, v14, 1, 1
    v_lshl_or_b32 v10, v15, 16, v10
    v_bfe_u32 v11, v14, 2, 1
    v_bfe_u32 v15, v14, 3, 1
    v_lshl_or_b32 v11, v15, 16, v11
    v_bfe_u32 v12, v14, 4, 1
    v_bfe_u32 v15, v14, 5, 1
    v_lshl_or_b32 v12, v15, 16, v12
    v_bfe_u32 v13, v14, 6, 1
    v_bfe_u32 v15, v14, 7, 1
    v_lshl_or_b32 v13, v15, 16, v13
    s_cmp_lt_u32 s4, 5
    s_cbranch_scc0 L_S7
    s_lshl_b32 s3, s37, 2
    s_add_u32 s3, s3, s38
    s_lshl_b32 s3, s3, 9
    s_add_u32 s3, s3, 393216
    v_mov_b32 v40, s3

L_sent:
    global_load_dwordx2 v[42:43], v40, s[34:35] sc1
    s_waitcnt vmcnt(0)
    v_cmp_ne_u32 vcc, s36, v43
    s_cbranch_vccz L_sent_done
    s_sleep 8

    s_sub_u32 s100, s100, 1
    s_cbranch_scc0 L_sent
    s_branch L_fail
L_sent_done:
    s_sleep 40
    s_branch L_S7
L_s6:
    s_mov_b32 s48, s18
    s_mov_b32 s49, s19
    s_mov_b32 s50, 5242880
    s_mov_b32 s51, 0x20000
    v_lshrrev_b32 v12, 3, v1
    v_mul_u32_u24 v50, 1280, v12
    v_and_b32 v12, 2, v12
    v_and_b32 v13, 7, v1
    v_xor_b32 v12, v12, v13
    v_lshl_add_u32 v50, v12, 4, v50
    v_xor_b32 v51, 64, v50
    s_lshl_b32 s3, s5, 3
    s_add_u32 s3, s3, s4
    s_mul_i32 s20, s3, 81920
    s_lshl_b32 s65, s6, 7
    s_add_u32 s20, s20, s65
    s_lshl_b32 s21, s4, 13

    s_mov_b32 m0, s21
    s_add_u32 s21, s21, 1024
    buffer_load_dwordx4 v50, s[48:51], s20 offen nt lds
    s_add_u32 s20, s20, 10240

    s_mov_b32 m0, s21
    s_add_u32 s21, s21, 1024
    buffer_load_dwordx4 v51, s[48:51], s20 offen nt lds
    s_add_u32 s20, s20, 10240

    s_mov_b32 m0, s21
    s_add_u32 s21, s21, 1024
    buffer_load_dwordx4 v50, s[48:51], s20 offen nt lds
    s_add_u32 s20, s20, 10240

    s_mov_b32 m0, s21
    s_add_u32 s21, s21, 1024
    buffer_load_dwordx4 v51, s[48:51], s20 offen nt lds
    s_add_u32 s20, s20, 10240

    s_mov_b32 m0, s21
    s_add_u32 s21, s21, 1024
    buffer_load_dwordx4 v50, s[48:51], s20 offen nt lds
    s_add_u32 s20, s20, 10240

    s_mov_b32 m0, s21
    s_add_u32 s21, s21, 1024
    buffer_load_dwordx4 v51, s[48:51], s20 offen nt lds
    s_add_u32 s20, s20, 10240

    s_mov_b32 m0, s21
    s_add_u32 s21, s21, 1024
    buffer_load_dwordx4 v50, s[48:51], s20 offen nt lds
    s_add_u32 s20, s20, 10240

    s_mov_b32 m0, s21
    s_add_u32 s21, s21, 1024
    buffer_load_dwordx4 v51, s[48:51], s20 offen nt lds
    s_add_u32 s20, s20, 10240

    s_mov_b32 s52, s22
    s_mov_b32 s53, s23
    s_mov_b32 s54, 3456
    s_mov_b32 s55, 0x20000
    s_mov_b32 s56, s24
    s_mov_b32 s57, s25
    s_mov_b32 s58, 3456
    s_mov_b32 s59, 0x20000
    s_mov_b32 s60, s26
    s_mov_b32 s61, s27
    s_mov_b32 s62, 3456
    s_mov_b32 s63, 0x20000
    s_lshl_b32 s3, s4, 8
    v_lshl_add_u32 v4, v1, 2, s3
    buffer_load_dword v224, v4, s[52:55], 0 offen
    buffer_load_dword v225, v4, s[52:55], 0 offen offset:2048
    buffer_load_dword v226, v4, s[56:59], 0 offen
    buffer_load_dword v227, v4, s[56:59], 0 offen offset:2048
    buffer_load_dword v228, v4, s[60:63], 0 offen
    buffer_load_dword v229, v4, s[60:63], 0 offen offset:2048
    v_mov_b32 v4, 0
    global_load_ushort v231, v4, s[28:29]

    s_min_u32 s3, s4, 4
    s_lshl_b32 s3, s3, 8
    v_lshlrev_b32 v4, 4, v3
    v_and_b32 v230, 1, v2
    v_lshl_add_u32 v4, v230, 3, v4
    v_lshrrev_b32 v230, 1, v2
    v_lshl_add_u32 v4, v230, 2, v4
    v_add_u32 v4, s3, v4
    global_load_dword v230, v4, s[8:9]

    v_bfe_u32 v62, v1, 2, 2
    v_bfe_u32 v63, v1, 1, 1
    v_and_b32 v59, 1, v1
    v_lshlrev_b32 v59, 3, v59

    v_lshl_add_u32 v12, v2, 3, v62
    v_lshlrev_b32 v12, 7, v12
    v_add_u32 v12, v12, v59
    s_lshl_b32 s3, s4, 13
    v_add_u32 v12, s3, v12
    v_and_b32 v13, 1, v2
    v_lshlrev_b32 v13, 2, v13
    v_and_b32 v14, 2, v62
    v_or_b32 v13, v13, v14
    v_xor_b32 v13, v13, v63
    v_lshl_add_u32 v249, v13, 4, v12
    v_xor_b32 v250, 32, v249
    v_xor_b32 v251, 64, v249
    v_xor_b32 v252, 96, v249
    s_lshr_b32 s3, s4, 1
    s_lshl_b32 s64, s5, 2
    s_add_u32 s3, s3, s64
    s_lshl_b32 s3, s3, 11
    s_and_b32 s64, s4, 1
    s_lshl_b32 s64, s64, 8
    s_add_u32 s3, s3, s64
    s_add_u32 s3, s3, 393216
    v_lshlrev_b32 v140, 9, v2
    v_lshl_add_u32 v140, v3, 4, v140
    v_add_u32 v140, s3, v140
    v_add_u32 v141, 196608, v140
    s_lshl_b32 s3, s4, 7
    s_add_u32 s3, s3, 146560
    v_lshl_add_u32 v142, v3, 2, v2
    v_lshlrev_b32 v142, 1, v142
    v_add_u32 v142, s3, v142
    v_lshl_add_u32 v143, v2, 4, s3
    s_lshl_b32 s3, s4, 8
    s_add_u32 s3, s3, 147584
    v_lshl_add_u32 v253, v2, 4, s3
    v_lshlrev_b32 v254, 3, v1
    v_add_u32 v254, 147584, v254
    s_mul_i32 s3, s5, 1280
    s_lshl_b32 s64, s6, 7
    s_add_u32 s3, s3, s64
    s_add_u32 s3, s3, 458752
    v_lshl_add_u32 v255, v1, 2, s3
    v_and_b32 v12, 15, v1
    v_lshlrev_b32 v12, 1, v12
    v_mov_b32 v13, s36
    v_lshrrev_b32 v12, v12, v13
    v_and_b32 v13, 1, v12
    v_and_b32 v12, 2, v12
    v_lshl_or_b32 v136, v12, 15, v13
    s_waitcnt vmcnt(0)

    v_lshlrev_b32 v232, 16, v224
    v_and_b32 v233, 0xffff0000, v224
    v_lshlrev_b32 v234, 16, v225
    v_and_b32 v235, 0xffff0000, v225
    v_lshlrev_b32 v236, 16, v226
    v_and_b32 v237, 0xffff0000, v226
    v_lshlrev_b32 v238, 16, v227
    v_and_b32 v239, 0xffff0000, v227
    v_lshlrev_b32 v240, 16, v228
    v_and_b32 v241, 0xffff0000, v228
    v_lshlrev_b32 v242, 16, v229
    v_and_b32 v243, 0xffff0000, v229
    v_mul_u32_u24 v244, 1280, v2
    v_lshl_add_u32 v244, v3, 4, v244
    s_lshl_b32 s3, s4, 8
    s_add_u32 s64, s3, 458752
    v_add_u32 v244, s64, v244
    v_add_u32 v245, 5120, v244
    s_lshl_b32 s3, s4, 9
    s_add_u32 s3, s3, 149632
    v_lshlrev_b32 v248, 5, v3
    v_and_b32 v57, 1, v2
    v_lshl_add_u32 v248, v57, 4, v248
    v_lshrrev_b32 v57, 1, v2
    v_lshl_add_u32 v248, v57, 3, v248
    v_add_u32 v248, s3, v248
    v_lshlrev_b32 v58, 16, v230
    v_and_b32 v59, 0xffff0000, v230
    v_mov_b32 v60, 0x3acccccd
    v_mov_b32 v61, 0x3f800054
    v_mov_b32 v65, 0x2edbe6ff
    v_mov_b32 v64, 0xc0135761
    v_mov_b32 v66, 0xbdd2d3e8
    v_mov_b32 v62, 152192
    s_lshr_b32 s101, s2, 3
    s_mul_i32 s101, s101, 3
    s_mul_i32 s3, s5, 80
    s_add_u32 s101, s101, s3
    s_lshl_b32 s3, s101, 2
    s_add_u32 s3, s3, 149632
    v_mov_b32 v63, s3
    s_lshl_b32 s3, s4, 3
    s_add_u32 s3, s3, 152192
    v_mov_b32 v68, s3
    s_lshl_b32 s3, s4, 4
    s_add_u32 s3, s3, 152256
    v_mov_b32 v69, s3
    v_mov_b32 v113, 0
    v_add_u32 v8, s101, v1
    v_lshlrev_b32 v6, 2, v1
    v_add_u32 v6, 152256, v6
    v_lshlrev_b32 v7, 2, v8
    v_add_u32 v7, 149632, v7
    v_lshlrev_b32 v9, 16, v231

    v_and_b32 v57, 3, v1
    v_lshlrev_b32 v14, 3, v57
    v_mov_b32 v15, s36
    v_lshrrev_b32 v14, v14, v15
    v_bfe_u32 v10, v14, 0, 1
    v_bfe_u32 v15, v14, 1, 1
    v_lshl_or_b32 v10, v15, 16, v10
    v_bfe_u32 v11, v14, 2, 1
    v_bfe_u32 v15, v14, 3, 1
    v_lshl_or_b32 v11, v15, 16, v11
    v_bfe_u32 v12, v14, 4, 1
    v_bfe_u32 v15, v14, 5, 1
    v_lshl_or_b32 v12, v15, 16, v12
    v_bfe_u32 v13, v14, 6, 1
    v_bfe_u32 v15, v14, 7, 1
    v_lshl_or_b32 v13, v15, 16, v13
    ds_read_b64_tr_b16 v[80:81], v249 offset:0
    ds_read_b64_tr_b16 v[82:83], v249 offset:512
    ds_read_b64_tr_b16 v[84:85], v249 offset:4096
    ds_read_b64_tr_b16 v[86:87], v249 offset:4608
    ds_read_b64_tr_b16 v[88:89], v250 offset:0
    ds_read_b64_tr_b16 v[90:91], v250 offset:512
    ds_read_b64_tr_b16 v[92:93], v250 offset:4096
    ds_read_b64_tr_b16 v[94:95], v250 offset:4608
    ds_read_b64_tr_b16 v[96:97], v251 offset:0
    ds_read_b64_tr_b16 v[98:99], v251 offset:512
    ds_read_b64_tr_b16 v[100:101], v251 offset:4096
    ds_read_b64_tr_b16 v[102:103], v251 offset:4608
    ds_read_b64_tr_b16 v[104:105], v252 offset:0
    ds_read_b64_tr_b16 v[106:107], v252 offset:512
    ds_read_b64_tr_b16 v[108:109], v252 offset:4096
    ds_read_b64_tr_b16 v[110:111], v252 offset:4608
    v_and_b32 v40, 15, v1
    v_lshlrev_b32 v40, 10, v40
    s_lshl_b32 s3, s5, 7
    s_add_u32 s3, s3, 196608
    v_add_u32 v40, s3, v40
    s_getreg_b32 s64, hwreg(HW_REG_XCC_ID, 0, 4)

L_xid:
    global_load_dwordx2 v[42:43], v40, s[34:35] sc1
    s_waitcnt vmcnt(0)
    v_cmp_ne_u32 vcc, s36, v43
    s_cbranch_vccz L_xid_ok
    s_sleep 4

    s_sub_u32 s100, s100, 1
    s_cbranch_scc0 L_xid
    s_branch L_fail
L_xid_ok:
    v_cmp_ne_u32 vcc, s64, v42
    s_cbranch_vccnz L_xid_slow
    v_mov_b32 v140, v141

L_xid_slow:
L_h4:
    global_load_dwordx4 v[40:43], v140, s[34:35] sc1
    s_waitcnt vmcnt(0)
    v_xor_b32 v48, s36, v41
    v_bitop3_b32 v48, v48, v43, s36 bitop3:0xf6
    v_cmp_ne_u32 vcc, 0, v48
    s_cbranch_vccz L_h4_done
    s_sub_u32 s100, s100, 1
    s_cbranch_scc0 L_h4
    s_branch L_fail
L_h4_done:
    v_lshlrev_b32 v44, 16, v40
    v_and_b32 v45, 0xffff0000, v40
    v_lshlrev_b32 v46, 16, v42
    v_and_b32 v47, 0xffff0000, v42
    s_nop 1
    v_permlane32_swap_b32 v44, v46
    v_permlane32_swap_b32 v45, v47
    v_add_f32 v44, v44, v46
    v_add_f32 v45, v45, v47
    s_nop 1
    v_permlane16_swap_b32 v44, v45
    v_add_f32 v44, v44, v45
    v_cvt_pk_bf16_f32 v44, v44, v44
    ds_write_b16 v142, v44
    s_waitcnt lgkmcnt(0)
    ds_read_b128 v[112:115], v143
    ds_read_b128 v[116:119], v143 offset:64

    s_waitcnt lgkmcnt(1)
    v_mfma_f32_16x16x32_bf16 v[120:123], v[80:83], v[112:115], 0
    v_mfma_f32_16x16x32_bf16 v[124:127], v[88:91], v[112:115], 0
    v_mfma_f32_16x16x32_bf16 v[128:131], v[96:99], v[112:115], 0
    v_mfma_f32_16x16x32_bf16 v[132:135], v[104:107], v[112:115], 0
    s_waitcnt lgkmcnt(0)
    v_mfma_f32_16x16x32_bf16 v[120:123], v[84:87], v[116:119], v[120:123]
    v_mfma_f32_16x16x32_bf16 v[124:127], v[92:95], v[116:119], v[124:127]
    v_mfma_f32_16x16x32_bf16 v[128:131], v[100:103], v[116:119], v[128:131]
    v_mfma_f32_16x16x32_bf16 v[132:135], v[108:111], v[116:119], v[132:135]
    s_mov_b32 exec_lo, 0x00010001
    s_mov_b32 exec_hi, 0x00010001
    s_nop 2
    ds_write_b128 v253, v[120:123] offset:0
    ds_write_b128 v253, v[124:127] offset:64
    ds_write_b128 v253, v[128:131] offset:128
    ds_write_b128 v253, v[132:135] offset:192
    s_mov_b64 exec, -1
    s_waitcnt lgkmcnt(0)
    s_barrier
    s_cmp_eq_u32 s4, 7
    s_cbranch_scc0 L_s6_w
    s_mov_b64 exec, 0xffffffff

    ds_read_b64 v[40:41], v254 offset:0
    ds_read_b64 v[42:43], v254 offset:256
    ds_read_b64 v[44:45], v254 offset:512
    ds_read_b64 v[46:47], v254 offset:768
    ds_read_b64 v[48:49], v254 offset:1024
    ds_read_b64 v[50:51], v254 offset:1280
    ds_read_b64 v[52:53], v254 offset:1536
    ds_read_b64 v[54:55], v254 offset:1792
    s_mov_b32 s66, 0xfffefffe
    s_waitcnt lgkmcnt(0)
    v_pk_add_f32 v[40:41], v[40:41], v[42:43]
    v_pk_add_f32 v[44:45], v[44:45], v[46:47]
    v_pk_add_f32 v[48:49], v[48:49], v[50:51]
    v_pk_add_f32 v[52:53], v[52:53], v[54:55]
    v_pk_add_f32 v[40:41], v[40:41], v[44:45]
    v_pk_add_f32 v[48:49], v[48:49], v[52:53]
    v_pk_add_f32 v[40:41], v[40:41], v[48:49]
    v_cvt_pk_bf16_f32 v56, v40, v41
    v_lshrrev_b32 v57, 1, v56
    v_and_b32 v57, 0x00010001, v57
    v_add_u32 v56, v56, v57
    v_and_or_b32 v56, v56, s66, v136
    global_store_dword v255, v56, s[34:35] sc1
    s_mov_b64 exec, -1

    s_branch L_S7
L_s6_w:
    s_sleep 14
    s_branch L_S7
L_B1:
    s_mov_b32 s7, 1
    s_lshr_b32 s3, s6, 2
    s_lshl_b32 s3, s3, 3
    s_add_u32 s3, s3, s4
    s_lshl_b32 s3, s3, 10
    s_add_u32 s3, s3, 327680
    v_lshl_add_u32 v5, v1, 4, s3
    s_mul_i32 s3, s4, 1056
    s_add_u32 s3, s3, 131072
    v_lshl_add_u32 v6, v1, 4, s3

    v_bfe_u32 v62, v1, 2, 2
    v_bfe_u32 v63, v1, 1, 1
    v_and_b32 v59, 1, v1
    v_lshlrev_b32 v59, 3, v59

    s_cmp_lt_u32 s4, 4
    s_cbranch_scc0 L_bp_prep
    s_lshl_b32 s3, s4, 5
    v_add_u32 v12, s3, v3
    v_lshlrev_b32 v12, 10, v12
    v_and_b32 v13, 7, v1
    v_lshlrev_b32 v13, 1, v13
    v_xor_b32 v13, v13, v2
    v_lshl_add_u32 v8, v13, 4, v12
    v_xor_b32 v9, 64, v8
    v_xor_b32 v10, 128, v8
    v_xor_b32 v11, 192, v8
    v_and_b32 v216, 7, v3
    v_lshlrev_b32 v217, 4, v216
    v_mul_u32_u24 v216, 1056, v216
    v_lshl_add_u32 v216, v2, 4, v216
    v_add_u32 v216, 131072, v216
    v_add_u32 v217, 143616, v217
    s_lshl_b32 s3, s4, 2
    v_add_u32 v218, s3, v217
    s_lshl_b32 s3, s4, 10
    s_add_u32 s3, s3, 139520
    v_lshl_add_u32 v219, v1, 4, s3
    v_and_b32 v220, 1, v2
    v_lshl_add_u32 v220, v220, 2, v62
    v_lshlrev_b32 v220, 1, v220
    s_lshl_b32 s3, s4, 2
    v_add_u32 v12, s3, v63
    v_xor_b32 v220, v220, v12
    v_lshl_add_u32 v220, v220, 4, v59
    v_lshl_add_u32 v12, v2, 3, v62
    v_lshl_add_u32 v220, v12, 8, v220
    v_xor_b32 v221, 32, v220
    s_lshl_b32 s3, s37, 10
    s_lshl_b32 s65, s38, 8
    s_add_u32 s3, s3, s65
    s_lshl_b32 s64, s4, 6
    s_add_u32 s3, s3, s64
    s_add_u32 s65, s3, 1048576
    s_lshl_b32 s64, s4, 7
    v_lshrrev_b32 v12, 2, v1
    v_and_b32 v13, 3, v1
    v_lshlrev_b32 v222, 15, v12
    v_lshl_add_u32 v222, v13, 4, v222
    v_add_u32 v222, s65, v222
    s_lshl_b32 s3, s37, 7
    s_add_u32 s3, s3, 786432
    v_lshlrev_b32 v48, 12, v12
    v_lshl_add_u32 v48, v13, 4, v48
    v_add_u32 v48, s3, v48
    v_bfe_u32 v223, v1, 3, 1
    v_lshlrev_b32 v223, 4, v223
    v_bfe_u32 v12, v1, 2, 1
    v_lshl_add_u32 v223, v12, 1, v223
    v_and_b32 v12, 1, v2
    v_add_u32 v223, v223, v12
    v_lshl_add_u32 v223, v13, 2, v223
    s_lshl_b32 s3, s4, 5
    v_add_u32 v223, s3, v223
    v_lshlrev_b32 v223, 1, v223
    v_add_u32 v223, 146304, v223
    v_lshlrev_b32 v49, 4, v2
    v_add_u32 v49, 146304, v49
    s_lshl_b32 s3, s37, 2
    s_add_u32 s3, s3, s38
    s_lshl_b32 s3, s3, 9
    s_add_u32 s3, s3, s64
    s_add_u32 s3, s3, 393216
    v_and_b32 v50, 1, v1
    v_lshlrev_b32 v50, 6, v50
    v_lshl_add_u32 v50, v2, 4, v50
    v_add_u32 v50, s3, v50
    v_add_u32 v51, 196608, v50
    s_waitcnt lgkmcnt(0)

    s_mul_i32 s36, s36, 1664525
    s_add_u32 s36, s36, 1013904223
    v_and_b32 v16, 3, v1
    s_mov_b32 s66, 0x00010001
    v_lshlrev_b32 v12, 3, v16
    v_mov_b32 v13, s36
    v_lshrrev_b32 v12, v12, v13
    v_bfe_u32 v44, v12, 0, 1
    v_bfe_u32 v13, v12, 1, 1
    v_lshl_or_b32 v44, v13, 16, v44
    v_bfe_u32 v45, v12, 2, 1
    v_bfe_u32 v13, v12, 3, 1
    v_lshl_or_b32 v45, v13, 16, v45
    v_bfe_u32 v46, v12, 4, 1
    v_bfe_u32 v13, v12, 5, 1
    v_lshl_or_b32 v46, v13, 16, v46
    v_bfe_u32 v47, v12, 6, 1
    v_bfe_u32 v13, v12, 7, 1
    v_lshl_or_b32 v47, v13, 16, v47
    s_waitcnt vmcnt(0)
    global_load_dwordx4 v[40:43], v5, s[34:35] sc1
    s_barrier
    ds_read_b128 v[64:67], v8 offset:0
    ds_read_b128 v[68:71], v9 offset:0
    ds_read_b128 v[72:75], v10 offset:0
    ds_read_b128 v[76:79], v11 offset:0
    ds_read_b128 v[80:83], v8 offset:256
    ds_read_b128 v[84:87], v9 offset:256
    ds_read_b128 v[88:91], v10 offset:256
    ds_read_b128 v[92:95], v11 offset:256
    ds_read_b128 v[96:99], v8 offset:512
    ds_read_b128 v[100:103], v9 offset:512
    ds_read_b128 v[104:107], v10 offset:512
    ds_read_b128 v[108:111], v11 offset:512
    ds_read_b128 v[112:115], v8 offset:768
    ds_read_b128 v[116:119], v9 offset:768
    ds_read_b128 v[120:123], v10 offset:768
    ds_read_b128 v[124:127], v11 offset:768
    ds_read_b128 v[128:131], v8 offset:16384
    ds_read_b128 v[132:135], v9 offset:16384
    ds_read_b128 v[136:139], v10 offset:16384
    ds_read_b128 v[140:143], v11 offset:16384
    ds_read_b128 v[144:147], v8 offset:16640
    ds_read_b128 v[148:151], v9 offset:16640
    ds_read_b128 v[152:155], v10 offset:16640
    ds_read_b128 v[156:159], v11 offset:16640
    ds_read_b128 v[160:163], v8 offset:16896
    ds_read_b128 v[164:167], v9 offset:16896
    ds_read_b128 v[168:171], v10 offset:16896
    ds_read_b128 v[172:175], v11 offset:16896
    ds_read_b128 v[176:179], v8 offset:17152
    ds_read_b128 v[180:183], v9 offset:17152
    ds_read_b128 v[184:187], v10 offset:17152
    ds_read_b128 v[188:191], v11 offset:17152
    s_waitcnt vmcnt(0)
    s_branch L_h2_chkq
L_h2q:
    global_load_dwordx4 v[40:43], v5, s[34:35] sc1
    s_waitcnt vmcnt(0)

L_h2_chkq:
    v_xor_b32 v40, v40, v44
    v_xor_b32 v41, v41, v45
    v_xor_b32 v42, v42, v46
    v_xor_b32 v43, v43, v47
    v_or3_b32 v4, v40, v41, v42
    v_or_b32 v4, v4, v43
    v_and_b32 v4, s66, v4
    v_cmp_ne_u32 vcc, 0, v4
    s_cbranch_vccz L_h2_doneq
    s_sub_u32 s100, s100, 1
    s_cbranch_scc0 L_h2q
    s_branch L_fail
L_h2_doneq:
    ds_write_b128 v6, v[40:43]
    s_waitcnt lgkmcnt(0)
    s_barrier

    ds_read_b128 v[192:195], v216 offset:0
    ds_read_b128 v[196:199], v216 offset:64
    ds_read_b128 v[200:203], v216 offset:128
    ds_read_b128 v[204:207], v216 offset:192
    ds_read_b128 v[208:211], v216 offset:256
    ds_read_b128 v[212:215], v216 offset:320
    ds_read_b128 v[12:15], v216 offset:384
    ds_read_b128 v[16:19], v216 offset:448
    ds_read_b128 v[20:23], v216 offset:512
    ds_read_b128 v[24:27], v216 offset:576
    ds_read_b128 v[28:31], v216 offset:640
    ds_read_b128 v[32:35], v216 offset:704
    ds_read_b128 v[36:39], v216 offset:768
    ds_read_b128 v[40:43], v216 offset:832
    ds_read_b128 v[44:47], v216 offset:896
    ds_read_b128 v[52:55], v216 offset:960
    s_waitcnt lgkmcnt(14)
    v_mfma_f32_16x16x32_bf16 v[56:59], v[64:67], v[192:195], 0
    v_mfma_f32_16x16x32_bf16 v[60:63], v[128:131], v[192:195], 0
    v_mfma_f32_16x16x32_bf16 v[56:59], v[68:71], v[196:199], v[56:59]
    v_mfma_f32_16x16x32_bf16 v[60:63], v[132:135], v[196:199], v[60:63]
    s_waitcnt lgkmcnt(12)
    v_mfma_f32_16x16x32_bf16 v[56:59], v[72:75], v[200:203], v[56:59]
    v_mfma_f32_16x16x32_bf16 v[60:63], v[136:139], v[200:203], v[60:63]
    v_mfma_f32_16x16x32_bf16 v[56:59], v[76:79], v[204:207], v[56:59]
    v_mfma_f32_16x16x32_bf16 v[60:63], v[140:143], v[204:207], v[60:63]
    s_waitcnt lgkmcnt(10)
    v_mfma_f32_16x16x32_bf16 v[56:59], v[80:83], v[208:211], v[56:59]
    v_mfma_f32_16x16x32_bf16 v[60:63], v[144:147], v[208:211], v[60:63]
    v_mfma_f32_16x16x32_bf16 v[56:59], v[84:87], v[212:215], v[56:59]
    v_mfma_f32_16x16x32_bf16 v[60:63], v[148:151], v[212:215], v[60:63]
    s_waitcnt lgkmcnt(8)
    v_mfma_f32_16x16x32_bf16 v[56:59], v[88:91], v[12:15], v[56:59]
    v_mfma_f32_16x16x32_bf16 v[60:63], v[152:155], v[12:15], v[60:63]
    v_mfma_f32_16x16x32_bf16 v[56:59], v[92:95], v[16:19], v[56:59]
    v_mfma_f32_16x16x32_bf16 v[60:63], v[156:159], v[16:19], v[60:63]
    s_waitcnt lgkmcnt(6)
    v_mfma_f32_16x16x32_bf16 v[56:59], v[96:99], v[20:23], v[56:59]
    v_mfma_f32_16x16x32_bf16 v[60:63], v[160:163], v[20:23], v[60:63]
    v_mfma_f32_16x16x32_bf16 v[56:59], v[100:103], v[24:27], v[56:59]
    v_mfma_f32_16x16x32_bf16 v[60:63], v[164:167], v[24:27], v[60:63]
    s_waitcnt lgkmcnt(4)
    v_mfma_f32_16x16x32_bf16 v[56:59], v[104:107], v[28:31], v[56:59]
    v_mfma_f32_16x16x32_bf16 v[60:63], v[168:171], v[28:31], v[60:63]
    v_mfma_f32_16x16x32_bf16 v[56:59], v[108:111], v[32:35], v[56:59]
    v_mfma_f32_16x16x32_bf16 v[60:63], v[172:175], v[32:35], v[60:63]
    s_waitcnt lgkmcnt(2)
    v_mfma_f32_16x16x32_bf16 v[56:59], v[112:115], v[36:39], v[56:59]
    v_mfma_f32_16x16x32_bf16 v[60:63], v[176:179], v[36:39], v[60:63]
    v_mfma_f32_16x16x32_bf16 v[56:59], v[116:119], v[40:43], v[56:59]
    v_mfma_f32_16x16x32_bf16 v[60:63], v[180:183], v[40:43], v[60:63]
    s_waitcnt lgkmcnt(0)
    v_mfma_f32_16x16x32_bf16 v[56:59], v[120:123], v[44:47], v[56:59]
    v_mfma_f32_16x16x32_bf16 v[60:63], v[184:187], v[44:47], v[60:63]
    v_mfma_f32_16x16x32_bf16 v[56:59], v[124:127], v[52:55], v[56:59]
    v_mfma_f32_16x16x32_bf16 v[60:63], v[188:191], v[52:55], v[60:63]
    s_nop 6
    v_max3_f32 v12, v56, v57, v58
    s_nop 0
    v_max3_f32 v13, v60, v61, v62
    v_max3_f32 v12, v59, v63, v12
    v_max_f32 v12, v12, v13
    v_mov_b32 v13, v12

    s_nop 1
    v_permlane16_swap_b32 v12, v13
    v_max_f32 v12, v12, v13
    v_mov_b32 v13, v12
    s_nop 1
    v_permlane32_swap_b32 v12, v13
    v_max_f32 v12, v12, v13
    s_mov_b64 exec, 0xff
    ds_write_b32 v218, v12
    s_mov_b64 exec, -1
    s_waitcnt lgkmcnt(0)
    s_barrier

    ds_read_b128 v[16:19], v217
    s_waitcnt lgkmcnt(0)
    v_max3_f32 v12, v16, v17, v18
    v_max_f32 v12, v12, v19

    v_sub_f32 v56, v56, v12
    v_sub_f32 v57, v57, v12
    v_sub_f32 v58, v58, v12
    v_sub_f32 v59, v59, v12
    v_sub_f32 v60, v60, v12
    v_sub_f32 v61, v61, v12
    v_sub_f32 v62, v62, v12
    v_sub_f32 v63, v63, v12
    v_exp_f32 v56, v56
    v_exp_f32 v57, v57
    v_exp_f32 v58, v58
    v_exp_f32 v59, v59
    v_exp_f32 v60, v60
    v_exp_f32 v61, v61
    v_exp_f32 v62, v62
    v_exp_f32 v63, v63
    s_nop 0
    v_cvt_pk_bf16_f32 v16, v56, v57
    v_cvt_pk_bf16_f32 v17, v58, v59
    v_cvt_pk_bf16_f32 v18, v60, v61
    v_cvt_pk_bf16_f32 v19, v62, v63
    ds_write_b128 v219, v[16:19]

    s_waitcnt lgkmcnt(0)
    s_barrier
    s_cmp_eq_u32 s4, 0
    s_cbranch_scc0 L_bq_nostat
    v_lshlrev_b32 v4, 4, v1
    v_add_u32 v4, 139520, v4
    ds_read_b128 v[20:23], v4
    ds_read_b128 v[24:27], v4 offset:1024
    ds_read_b128 v[28:31], v4 offset:2048
    ds_read_b128 v[32:35], v4 offset:3072
    v_mov_b32 v36, 0x3f803f80
    v_mov_b32 v37, 0x3f803f80
    v_mov_b32 v38, 0x3f803f80
    v_mov_b32 v39, 0x3f803f80
    v_bfe_u32 v5, v1, 2, 3
    v_lshlrev_b32 v5, 2, v5
    ds_bpermute_b32 v52, v5, v12
    v_mov_b32 v53, s36
    v_mov_b32 v55, s36
    s_lshr_b32 s64, s6, 2
    s_lshl_b32 s64, s64, 10
    s_lshl_b32 s65, s39, 12
    s_add_u32 s64, s64, s65
    s_add_u32 s64, s64, 786432
    v_lshrrev_b32 v6, 2, v1
    v_lshlrev_b32 v6, 7, v6
    v_and_b32 v4, 3, v1
    v_lshl_add_u32 v6, v4, 4, v6
    v_add_u32 v6, s64, v6

    s_waitcnt lgkmcnt(4)
    v_mfma_f32_16x16x32_bf16 v[40:43], v[36:39], v[20:23], 0
    s_waitcnt lgkmcnt(3)
    v_mfma_f32_16x16x32_bf16 v[40:43], v[36:39], v[24:27], v[40:43]
    s_waitcnt lgkmcnt(2)
    v_mfma_f32_16x16x32_bf16 v[40:43], v[36:39], v[28:31], v[40:43]
    s_waitcnt lgkmcnt(0)
    v_mfma_f32_16x16x32_bf16 v[40:43], v[36:39], v[32:35], v[40:43]
    s_nop 7
    ds_bpermute_b32 v54, v5, v40
    s_mov_b64 exec, 0xffffffff
    s_waitcnt lgkmcnt(0)
    global_store_dwordx4 v6, v[52:55], s[34:35] sc1
    s_mov_b64 exec, -1

L_bq_nostat:
    v_mov_b32 v105, s36
    v_mov_b32 v107, s36
    v_add_u32 v192, 0x80000, v222
    v_add_u32 v195, 0x10000, v48
    v_and_b32 v196, 3, v1
    s_mov_b32 s66, 0x00010001
    s_mov_b32 s67, 0x3f805c55
    s_mov_b32 s64, 0xaaaaaaaa
    s_mov_b32 s65, 0xaaaaaaaa

    s_barrier
    ds_read_b64_tr_b16 v[128:129], v220 offset:0
    ds_read_b64_tr_b16 v[130:131], v220 offset:1024
    ds_read_b64_tr_b16 v[132:133], v220 offset:8192
    ds_read_b64_tr_b16 v[134:135], v220 offset:9216
    ds_read_b64_tr_b16 v[136:137], v220 offset:16384
    ds_read_b64_tr_b16 v[138:139], v220 offset:17408
    ds_read_b64_tr_b16 v[140:141], v220 offset:24576
    ds_read_b64_tr_b16 v[142:143], v220 offset:25600
    ds_read_b64_tr_b16 v[144:145], v221 offset:0
    ds_read_b64_tr_b16 v[146:147], v221 offset:1024
    ds_read_b64_tr_b16 v[148:149], v221 offset:8192
    ds_read_b64_tr_b16 v[150:151], v221 offset:9216
    ds_read_b64_tr_b16 v[152:153], v221 offset:16384
    ds_read_b64_tr_b16 v[154:155], v221 offset:17408
    ds_read_b64_tr_b16 v[156:157], v221 offset:24576
    ds_read_b64_tr_b16 v[158:159], v221 offset:25600
    v_lshlrev_b32 v202, 3, v196
    v_mov_b32 v203, s36
    v_lshrrev_b32 v202, v202, v203
    v_bfe_u32 v198, v202, 0, 1
    v_bfe_u32 v203, v202, 1, 1
    v_lshl_or_b32 v198, v203, 16, v198
    v_bfe_u32 v199, v202, 2, 1
    v_bfe_u32 v203, v202, 3, 1
    v_lshl_or_b32 v199, v203, 16, v199
    v_bfe_u32 v200, v202, 4, 1
    v_bfe_u32 v203, v202, 5, 1
    v_lshl_or_b32 v200, v203, 16, v200
    v_bfe_u32 v201, v202, 6, 1
    v_bfe_u32 v203, v202, 7, 1
    v_lshl_or_b32 v201, v203, 16, v201
    s_sleep 13
L_h3:
    global_load_dwordx4 v[64:67], v48, s[34:35] sc1
    global_load_dwordx4 v[68:71], v195, s[34:35] sc1
    global_load_dwordx4 v[80:83], v222, s[34:35] sc1
    global_load_dwordx4 v[84:87], v192, s[34:35] sc1
    s_waitcnt vmcnt(2)

    v_xor_b32 v4, s36, v65
    v_bitop3_b32 v4, v4, v67, s36 bitop3:0xf6
    v_bitop3_b32 v4, v4, v69, s36 bitop3:0xf6
    v_bitop3_b32 v4, v4, v71, s36 bitop3:0xf6
    v_cmp_ne_u32 vcc, 0, v4
    s_cbranch_vccz L_h3_st
    s_waitcnt vmcnt(0)
    s_sub_u32 s100, s100, 1
    s_cbranch_scc0 L_h3
    s_branch L_fail
L_h3_st:
    v_max_f32 v4, v64, v68
    s_nop 1
    v_max_f32_dpp v4, v4, v4 row_ror:4 row_mask:0xf bank_mask:0xf
    s_nop 1
    v_max_f32_dpp v4, v4, v4 row_ror:8 row_mask:0xf bank_mask:0xf
    s_nop 0
    v_mov_b32 v5, v4
    s_nop 1
    v_permlane16_swap_b32 v4, v5
    v_max_f32 v4, v4, v5
    v_mov_b32 v5, v4
    s_nop 1
    v_permlane32_swap_b32 v4, v5
    v_max_f32 v4, v4, v5
    v_sub_f32 v64, v64, v4
    v_sub_f32 v68, v68, v4
    v_exp_f32 v64, v64
    v_exp_f32 v68, v68
    s_nop 0
    v_mul_f32 v28, v64, v66
    v_fmac_f32 v28, v68, v70
    s_nop 1
    v_add_f32_dpp v28, v28, v28 row_ror:4 row_mask:0xf bank_mask:0xf
    s_nop 1
    v_add_f32_dpp v28, v28, v28 row_ror:8 row_mask:0xf bank_mask:0xf
    s_nop 0
    v_mov_b32 v29, v28
    s_nop 1
    v_permlane16_swap_b32 v28, v29
    v_add_f32 v28, v28, v29
    v_mov_b32 v29, v28
    s_nop 1
    v_permlane32_swap_b32 v28, v29
    v_add_f32 v28, v28, v29
    v_rcp_f32 v28, v28
    v_mul_f32 v64, s67, v64
    v_mul_f32 v68, s67, v68
    v_mul_f32 v64, v64, v28
    v_mul_f32 v68, v68, v28
    s_waitcnt vmcnt(0)
    s_branch L_h3_dchk

L_h3d:
    global_load_dwordx4 v[80:83], v222, s[34:35] sc1
    global_load_dwordx4 v[84:87], v192, s[34:35] sc1
    s_waitcnt vmcnt(0)

L_h3_dchk:
    v_xor_b32 v80, v80, v198
    v_xor_b32 v81, v81, v199
    v_xor_b32 v82, v82, v200
    v_xor_b32 v83, v83, v201
    v_xor_b32 v84, v84, v198
    v_xor_b32 v85, v85, v199
    v_xor_b32 v86, v86, v200
    v_xor_b32 v87, v87, v201
    v_or3_b32 v4, v80, v81, v82
    v_or3_b32 v5, v83, v84, v85
    v_or3_b32 v4, v86, v87, v4
    v_or_b32 v4, v4, v5
    v_and_b32 v4, s66, v4
    v_cmp_ne_u32 vcc, 0, v4
    s_cbranch_vccz L_h3_done
    s_sub_u32 s100, s100, 1
    s_cbranch_scc0 L_h3d
    s_branch L_fail
L_h3_done:
    v_lshlrev_b32 v12, 16, v80
    v_and_b32 v13, 0xffff0000, v80
    v_lshlrev_b32 v14, 16, v81
    v_and_b32 v15, 0xffff0000, v81
    v_lshlrev_b32 v16, 16, v82
    v_and_b32 v17, 0xffff0000, v82
    v_lshlrev_b32 v18, 16, v83
    v_and_b32 v19, 0xffff0000, v83
    v_lshlrev_b32 v20, 16, v84
    v_and_b32 v21, 0xffff0000, v84
    v_pk_mul_f32 v[12:13], v[12:13], v[64:65] op_sel_hi:[1,0]
    v_lshlrev_b32 v22, 16, v85
    v_and_b32 v23, 0xffff0000, v85
    v_pk_mul_f32 v[14:15], v[14:15], v[64:65] op_sel_hi:[1,0]
    v_lshlrev_b32 v24, 16, v86
    v_and_b32 v25, 0xffff0000, v86
    v_pk_mul_f32 v[16:17], v[16:17], v[64:65] op_sel_hi:[1,0]
    v_lshlrev_b32 v26, 16, v87
    v_and_b32 v27, 0xffff0000, v87
    v_pk_mul_f32 v[18:19], v[18:19], v[64:65] op_sel_hi:[1,0]
    v_pk_fma_f32 v[12:13], v[20:21], v[68:69], v[12:13] op_sel_hi:[1,0,1]
    v_pk_fma_f32 v[14:15], v[22:23], v[68:69], v[14:15] op_sel_hi:[1,0,1]
    v_pk_fma_f32 v[16:17], v[24:25], v[68:69], v[16:17] op_sel_hi:[1,0,1]
    v_pk_fma_f32 v[18:19], v[26:27], v[68:69], v[18:19] op_sel_hi:[1,0,1]
    s_nop 0
    v_add_f32_dpp v28, v12, v12 row_ror:8 row_mask:0xf bank_mask:0x3
    v_add_f32_dpp v28, v16, v16 row_ror:8 row_mask:0xf bank_mask:0xc
    v_add_f32_dpp v29, v13, v13 row_ror:8 row_mask:0xf bank_mask:0x3
    v_add_f32_dpp v29, v17, v17 row_ror:8 row_mask:0xf bank_mask:0xc
    v_add_f32_dpp v30, v14, v14 row_ror:8 row_mask:0xf bank_mask:0x3
    v_add_f32_dpp v30, v18, v18 row_ror:8 row_mask:0xf bank_mask:0xc
    v_add_f32_dpp v31, v15, v15 row_ror:8 row_mask:0xf bank_mask:0x3
    v_add_f32_dpp v31, v19, v19 row_ror:8 row_mask:0xf bank_mask:0xc
    s_nop 0
    v_add_f32_dpp v12, v28, v28 row_ror:12 row_mask:0xf bank_mask:0x5
    v_add_f32_dpp v12, v30, v30 row_ror:4 row_mask:0xf bank_mask:0xa
    v_add_f32_dpp v13, v29, v29 row_ror:12 row_mask:0xf bank_mask:0x5
    v_add_f32_dpp v13, v31, v31 row_ror:4 row_mask:0xf bank_mask:0xa
    s_nop 1
    v_permlane16_swap_b32 v12, v13
    v_add_f32 v12, v12, v13
    v_mov_b32 v13, v12
    s_nop 1
    v_permlane32_swap_b32 v12, v13
    s_mov_b64 exec, 0xffffffff
    v_add_f32 v12, v12, v13
    v_cvt_pk_bf16_f32 v12, v12, v12
    ds_write_b16 v223, v12
    s_mov_b64 exec, -1
    s_waitcnt lgkmcnt(0)
    s_barrier

    ds_read_b128 v[112:115], v49 offset:0
    ds_read_b128 v[116:119], v49 offset:64
    ds_read_b128 v[120:123], v49 offset:128
    ds_read_b128 v[124:127], v49 offset:192
    s_waitcnt lgkmcnt(3)
    v_mfma_f32_16x16x32_bf16 v[96:99], v[128:131], v[112:115], 0
    v_mfma_f32_16x16x32_bf16 v[100:103], v[144:147], v[112:115], 0
    s_waitcnt lgkmcnt(2)
    v_mfma_f32_16x16x32_bf16 v[96:99], v[132:135], v[116:119], v[96:99]
    v_mfma_f32_16x16x32_bf16 v[100:103], v[148:151], v[116:119], v[100:103]
    s_waitcnt lgkmcnt(1)
    v_mfma_f32_16x16x32_bf16 v[96:99], v[136:139], v[120:123], v[96:99]
    v_mfma_f32_16x16x32_bf16 v[100:103], v[152:155], v[120:123], v[100:103]
    s_waitcnt lgkmcnt(0)
    v_mfma_f32_16x16x32_bf16 v[96:99], v[140:143], v[124:127], v[96:99]
    v_mfma_f32_16x16x32_bf16 v[100:103], v[156:159], v[124:127], v[100:103]
    s_mov_b32 exec_lo, 0x00030003
    s_mov_b32 exec_hi, 0x00030003
    s_nop 5
    v_cndmask_b32 v96, v96, v100, s[64:65]
    v_cndmask_b32 v97, v97, v101, s[64:65]
    v_cndmask_b32 v98, v98, v102, s[64:65]
    v_cndmask_b32 v99, v99, v103, s[64:65]
    v_cvt_pk_bf16_f32 v104, v96, v97
    v_cvt_pk_bf16_f32 v106, v98, v99

    global_store_dwordx4 v51, v[104:107], s[34:35]
    global_store_dwordx4 v50, v[104:107], s[34:35] sc1
    s_mov_b64 exec, -1
    s_branch L_b_tail
L_bp_prep:
    v_lshl_add_u32 v58, v2, 2, v62
    v_and_b32 v13, 7, v58
    v_lshlrev_b32 v13, 1, v13
    v_lshlrev_b32 v58, 10, v58
    v_add_u32 v58, v58, v59
    s_and_b32 s66, s4, 3
    s_lshl_b32 s3, s66, 4
    v_add_u32 v12, s3, v63
    v_xor_b32 v12, v12, v13
    v_lshl_add_u32 v8, v12, 4, v58

    v_xor_b32 v9, 32, v8
    v_xor_b32 v10, 64, v8
    v_xor_b32 v11, 96, v8
    v_xor_b32 v12, 128, v8
    v_xor_b32 v13, 160, v8
    v_xor_b32 v14, 192, v8
    v_xor_b32 v15, 224, v8
    v_lshlrev_b32 v16, 4, v1
    v_add_u32 v16, 139520, v16
    s_mov_b32 s44, s16
    s_mov_b32 s45, s17
    s_mov_b32 s46, 4194304
    s_mov_b32 s47, 0x20000
    s_lshl_b32 s3, s4, 2
    s_and_b32 s3, s3, 8
    v_lshlrev_b32 v19, 1, v2
    v_xor_b32 v19, v19, v3
    v_xor_b32 v19, s3, v19
    v_lshlrev_b32 v19, 4, v19
    v_lshl_add_u32 v19, v2, 13, v19
    s_lshl_b32 s20, s38, 5
    s_add_u32 s20, s20, s66
    s_lshl_b32 s20, s20, 15
    s_lshl_b32 s21, s37, 8
    s_add_u32 s20, s20, s21
    s_lshl_b32 s21, s66, 10
    v_lshl_add_u32 v56, v1, 4, s21
    s_lshl_b32 s3, s39, 15
    s_lshr_b32 s64, s6, 2
    s_lshl_b32 s65, s64, 13
    s_add_u32 s3, s3, s65
    s_lshl_b32 s65, s66, 8
    s_add_u32 s3, s3, s65
    s_add_u32 s3, s3, 1048576
    v_and_b32 v17, 7, v3
    v_lshlrev_b32 v17, 10, v17
    v_lshl_add_u32 v17, v2, 4, v17
    v_lshrrev_b32 v20, 3, v3
    v_lshl_add_u32 v17, v20, 6, v17
    v_add_u32 v17, s3, v17
    s_lshl_b32 s64, s64, 10
    s_lshl_b32 s65, s39, 12
    s_add_u32 s64, s64, s65
    s_add_u32 s64, s64, 786432
    v_lshrrev_b32 v18, 2, v1
    v_lshlrev_b32 v18, 7, v18
    v_and_b32 v20, 3, v1
    v_lshl_add_u32 v18, v20, 4, v18
    v_add_u32 v18, s64, v18
    v_mov_b32 v36, 0x3f803f80
    v_mov_b32 v37, 0x3f803f80
    v_mov_b32 v38, 0x3f803f80
    v_mov_b32 v39, 0x3f803f80
    s_waitcnt lgkmcnt(0)

    s_mul_i32 s36, s36, 1664525
    s_add_u32 s36, s36, 1013904223
    v_and_b32 v50, 3, v1
    s_mov_b32 s67, 0x00010001
    v_lshlrev_b32 v48, 3, v50
    v_mov_b32 v49, s36
    v_lshrrev_b32 v48, v48, v49
    v_bfe_u32 v44, v48, 0, 1
    v_bfe_u32 v49, v48, 1, 1
    v_lshl_or_b32 v44, v49, 16, v44
    v_bfe_u32 v45, v48, 2, 1
    v_bfe_u32 v49, v48, 3, 1
    v_lshl_or_b32 v45, v49, 16, v45
    v_bfe_u32 v46, v48, 4, 1
    v_bfe_u32 v49, v48, 5, 1
    v_lshl_or_b32 v46, v49, 16, v46
    v_bfe_u32 v47, v48, 6, 1
    v_bfe_u32 v49, v48, 7, 1
    v_lshl_or_b32 v47, v49, 16, v47
    v_mov_b32 v53, s36
    v_mov_b32 v55, s36
    v_lshlrev_b32 v61, 3, v2
    v_mov_b32 v62, s36
    v_lshrrev_b32 v61, v61, v62
    v_bfe_u32 v57, v61, 0, 1
    v_bfe_u32 v62, v61, 1, 1
    v_lshl_or_b32 v57, v62, 16, v57
    v_bfe_u32 v58, v61, 2, 1
    v_bfe_u32 v62, v61, 3, 1
    v_lshl_or_b32 v58, v62, 16, v58
    v_bfe_u32 v59, v61, 4, 1
    v_bfe_u32 v62, v61, 5, 1
    v_lshl_or_b32 v59, v62, 16, v59
    v_bfe_u32 v60, v61, 6, 1
    v_bfe_u32 v62, v61, 7, 1
    v_lshl_or_b32 v60, v62, 16, v60
    s_waitcnt vmcnt(0)
    global_load_dwordx4 v[40:43], v5, s[34:35] sc1
    s_barrier
    s_cmp_eq_u32 s4, 7
    s_cbranch_scc0 L_noxid
    s_getreg_b32 s3, hwreg(HW_REG_XCC_ID, 0, 4)
    v_mov_b32 v224, s3
    v_mov_b32 v225, s36
    v_mov_b32 v226, s3
    v_mov_b32 v227, s36
    s_and_b32 s3, s2, 127
    s_lshl_b32 s3, s3, 7
    s_add_u32 s3, s3, 196608
    v_lshl_add_u32 v228, v1, 4, s3
    s_mov_b64 exec, 0xf
    global_store_dwordx4 v228, v[224:227], s[34:35] sc1
    s_mov_b64 exec, -1

L_noxid:
    ds_read_b64_tr_b16 v[64:65], v8 offset:0
    ds_read_b64_tr_b16 v[66:67], v8 offset:16384
    ds_read_b64_tr_b16 v[68:69], v8 offset:32768
    ds_read_b64_tr_b16 v[70:71], v8 offset:49152
    ds_read_b64_tr_b16 v[80:81], v9 offset:0
    ds_read_b64_tr_b16 v[82:83], v9 offset:16384
    ds_read_b64_tr_b16 v[84:85], v9 offset:32768
    ds_read_b64_tr_b16 v[86:87], v9 offset:49152
    ds_read_b64_tr_b16 v[96:97], v10 offset:0
    ds_read_b64_tr_b16 v[98:99], v10 offset:16384
    ds_read_b64_tr_b16 v[100:101], v10 offset:32768
    ds_read_b64_tr_b16 v[102:103], v10 offset:49152
    ds_read_b64_tr_b16 v[112:113], v11 offset:0
    ds_read_b64_tr_b16 v[114:115], v11 offset:16384
    ds_read_b64_tr_b16 v[116:117], v11 offset:32768
    ds_read_b64_tr_b16 v[118:119], v11 offset:49152
    ds_read_b64_tr_b16 v[128:129], v12 offset:0
    ds_read_b64_tr_b16 v[130:131], v12 offset:16384
    ds_read_b64_tr_b16 v[132:133], v12 offset:32768
    ds_read_b64_tr_b16 v[134:135], v12 offset:49152
    ds_read_b64_tr_b16 v[144:145], v13 offset:0
    ds_read_b64_tr_b16 v[146:147], v13 offset:16384
    ds_read_b64_tr_b16 v[148:149], v13 offset:32768
    ds_read_b64_tr_b16 v[150:151], v13 offset:49152
    ds_read_b64_tr_b16 v[160:161], v14 offset:0
    ds_read_b64_tr_b16 v[162:163], v14 offset:16384
    ds_read_b64_tr_b16 v[164:165], v14 offset:32768
    ds_read_b64_tr_b16 v[166:167], v14 offset:49152
    ds_read_b64_tr_b16 v[176:177], v15 offset:0
    ds_read_b64_tr_b16 v[178:179], v15 offset:16384
    ds_read_b64_tr_b16 v[180:181], v15 offset:32768
    ds_read_b64_tr_b16 v[182:183], v15 offset:49152
    v_add_u32 v8, 0x10000, v8
    v_add_u32 v9, 0x10000, v9
    v_add_u32 v10, 0x10000, v10
    v_add_u32 v11, 0x10000, v11
    v_add_u32 v12, 0x10000, v12
    v_add_u32 v13, 0x10000, v13
    v_add_u32 v14, 0x10000, v14
    v_add_u32 v15, 0x10000, v15
    ds_read_b64_tr_b16 v[72:73], v8 offset:0
    ds_read_b64_tr_b16 v[74:75], v8 offset:16384
    ds_read_b64_tr_b16 v[76:77], v8 offset:32768
    ds_read_b64_tr_b16 v[78:79], v8 offset:49152
    ds_read_b64_tr_b16 v[88:89], v9 offset:0
    ds_read_b64_tr_b16 v[90:91], v9 offset:16384
    ds_read_b64_tr_b16 v[92:93], v9 offset:32768
    ds_read_b64_tr_b16 v[94:95], v9 offset:49152
    ds_read_b64_tr_b16 v[104:105], v10 offset:0
    ds_read_b64_tr_b16 v[106:107], v10 offset:16384
    ds_read_b64_tr_b16 v[108:109], v10 offset:32768
    ds_read_b64_tr_b16 v[110:111], v10 offset:49152
    ds_read_b64_tr_b16 v[120:121], v11 offset:0
    ds_read_b64_tr_b16 v[122:123], v11 offset:16384
    ds_read_b64_tr_b16 v[124:125], v11 offset:32768
    ds_read_b64_tr_b16 v[126:127], v11 offset:49152
    ds_read_b64_tr_b16 v[136:137], v12 offset:0
    ds_read_b64_tr_b16 v[138:139], v12 offset:16384
    ds_read_b64_tr_b16 v[140:141], v12 offset:32768
    ds_read_b64_tr_b16 v[142:143], v12 offset:49152
    ds_read_b64_tr_b16 v[152:153], v13 offset:0
    ds_read_b64_tr_b16 v[154:155], v13 offset:16384
    ds_read_b64_tr_b16 v[156:157], v13 offset:32768
    ds_read_b64_tr_b16 v[158:159], v13 offset:49152
    ds_read_b64_tr_b16 v[168:169], v14 offset:0
    ds_read_b64_tr_b16 v[170:171], v14 offset:16384
    ds_read_b64_tr_b16 v[172:173], v14 offset:32768
    ds_read_b64_tr_b16 v[174:175], v14 offset:49152
    ds_read_b64_tr_b16 v[184:185], v15 offset:0
    ds_read_b64_tr_b16 v[186:187], v15 offset:16384
    ds_read_b64_tr_b16 v[188:189], v15 offset:32768
    ds_read_b64_tr_b16 v[190:191], v15 offset:49152
    s_waitcnt vmcnt(0)
    s_branch L_h2_chkp
L_h2p:
    global_load_dwordx4 v[40:43], v5, s[34:35] sc1
    s_waitcnt vmcnt(0)

L_h2_chkp:
    v_xor_b32 v40, v40, v44
    v_xor_b32 v41, v41, v45
    v_xor_b32 v42, v42, v46
    v_xor_b32 v43, v43, v47
    v_or3_b32 v4, v40, v41, v42
    v_or_b32 v4, v4, v43
    v_and_b32 v4, s67, v4
    v_cmp_ne_u32 vcc, 0, v4
    s_cbranch_vccz L_h2_donep
    s_sub_u32 s100, s100, 1
    s_cbranch_scc0 L_h2p
    s_branch L_fail
L_h2_donep:
    ds_write_b128 v6, v[40:43]
    s_waitcnt lgkmcnt(0)
    s_barrier

    s_mov_b32 m0, s21
    s_add_u32 s21, s21, 4096
    buffer_load_dwordx4 v19, s[44:47], s20 offen nt lds
    s_add_u32 s20, s20, 131072

    s_mov_b32 m0, s21
    s_add_u32 s21, s21, 4096
    buffer_load_dwordx4 v19, s[44:47], s20 offen nt lds
    s_add_u32 s20, s20, 131072

    s_mov_b32 m0, s21
    s_add_u32 s21, s21, 4096
    buffer_load_dwordx4 v19, s[44:47], s20 offen nt lds
    s_add_u32 s20, s20, 131072

    s_mov_b32 m0, s21
    s_add_u32 s21, s21, 4096
    buffer_load_dwordx4 v19, s[44:47], s20 offen nt lds
    s_add_u32 s20, s20, 131072

    s_mov_b32 m0, s21
    s_add_u32 s21, s21, 4096
    buffer_load_dwordx4 v19, s[44:47], s20 offen nt lds
    s_add_u32 s20, s20, 131072

    s_mov_b32 m0, s21
    s_add_u32 s21, s21, 4096
    buffer_load_dwordx4 v19, s[44:47], s20 offen nt lds
    s_add_u32 s20, s20, 131072

    s_mov_b32 m0, s21
    s_add_u32 s21, s21, 4096
    buffer_load_dwordx4 v19, s[44:47], s20 offen nt lds
    s_add_u32 s20, s20, 131072

    s_mov_b32 m0, s21
    s_add_u32 s21, s21, 4096
    buffer_load_dwordx4 v19, s[44:47], s20 offen nt lds
    s_add_u32 s20, s20, 131072

    s_barrier
    s_barrier
    ds_read_b128 v[20:23], v16 offset:0
    ds_read_b128 v[24:27], v16 offset:1024
    ds_read_b128 v[28:31], v16 offset:2048
    ds_read_b128 v[32:35], v16 offset:3072
    v_bfe_u32 v5, v1, 2, 3
    v_lshlrev_b32 v4, 4, v5
    v_add_u32 v4, 143744, v4
    v_lshlrev_b32 v5, 2, v5
    s_mov_b32 s64, 0xff00ff00
    s_mov_b32 s65, 0xff00ff00

    s_mov_b32 s66, 0xfffefffe
    s_waitcnt lgkmcnt(3)
    v_mfma_f32_16x16x32_bf16 v[192:195], v[64:67], v[20:23], 0
    v_mfma_f32_16x16x32_bf16 v[196:199], v[80:83], v[20:23], 0
    v_mfma_f32_16x16x32_bf16 v[200:203], v[96:99], v[20:23], 0
    v_mfma_f32_16x16x32_bf16 v[204:207], v[112:115], v[20:23], 0
    s_waitcnt lgkmcnt(2)
    v_mfma_f32_16x16x32_bf16 v[192:195], v[68:71], v[24:27], v[192:195]
    v_mfma_f32_16x16x32_bf16 v[196:199], v[84:87], v[24:27], v[196:199]
    v_mfma_f32_16x16x32_bf16 v[200:203], v[100:103], v[24:27], v[200:203]
    v_mfma_f32_16x16x32_bf16 v[204:207], v[116:119], v[24:27], v[204:207]
    s_waitcnt lgkmcnt(1)
    v_mfma_f32_16x16x32_bf16 v[192:195], v[72:75], v[28:31], v[192:195]
    v_mfma_f32_16x16x32_bf16 v[196:199], v[88:91], v[28:31], v[196:199]
    v_mfma_f32_16x16x32_bf16 v[200:203], v[104:107], v[28:31], v[200:203]
    v_mfma_f32_16x16x32_bf16 v[204:207], v[120:123], v[28:31], v[204:207]
    s_waitcnt lgkmcnt(0)
    v_mfma_f32_16x16x32_bf16 v[192:195], v[76:79], v[32:35], v[192:195]
    v_mfma_f32_16x16x32_bf16 v[196:199], v[92:95], v[32:35], v[196:199]
    v_mfma_f32_16x16x32_bf16 v[200:203], v[108:111], v[32:35], v[200:203]
    v_mfma_f32_16x16x32_bf16 v[204:207], v[124:127], v[32:35], v[204:207]
    v_mfma_f32_16x16x32_bf16 v[208:211], v[128:131], v[20:23], 0
    v_mfma_f32_16x16x32_bf16 v[212:215], v[144:147], v[20:23], 0
    v_mfma_f32_16x16x32_bf16 v[216:219], v[160:163], v[20:23], 0
    v_mfma_f32_16x16x32_bf16 v[220:223], v[176:179], v[20:23], 0
    v_mfma_f32_16x16x32_bf16 v[208:211], v[132:135], v[24:27], v[208:211]
    v_mfma_f32_16x16x32_bf16 v[212:215], v[148:151], v[24:27], v[212:215]
    v_mfma_f32_16x16x32_bf16 v[216:219], v[164:167], v[24:27], v[216:219]
    v_mfma_f32_16x16x32_bf16 v[220:223], v[180:183], v[24:27], v[220:223]
    v_cvt_pk_bf16_f32 v44, v192, v193
    v_cvt_pk_bf16_f32 v45, v194, v195
    v_mfma_f32_16x16x32_bf16 v[208:211], v[136:139], v[28:31], v[208:211]
    v_cvt_pk_bf16_f32 v46, v196, v197
    v_cvt_pk_bf16_f32 v47, v198, v199
    v_mfma_f32_16x16x32_bf16 v[212:215], v[152:155], v[28:31], v[212:215]
    v_cvt_pk_bf16_f32 v48, v200, v201
    v_cvt_pk_bf16_f32 v49, v202, v203
    v_mfma_f32_16x16x32_bf16 v[216:219], v[168:171], v[28:31], v[216:219]
    v_cvt_pk_bf16_f32 v50, v204, v205
    v_cvt_pk_bf16_f32 v51, v206, v207
    v_mfma_f32_16x16x32_bf16 v[220:223], v[184:187], v[28:31], v[220:223]
    v_cndmask_b32 v64, v44, v48, s[64:65]
    v_cndmask_b32 v65, v45, v49, s[64:65]
    v_mfma_f32_16x16x32_bf16 v[208:211], v[140:143], v[32:35], v[208:211]
    v_cndmask_b32 v66, v46, v50, s[64:65]
    v_cndmask_b32 v67, v47, v51, s[64:65]
    v_mfma_f32_16x16x32_bf16 v[212:215], v[156:159], v[32:35], v[212:215]
    v_and_or_b32 v64, v64, s66, v57
    v_and_or_b32 v65, v65, s66, v58
    v_mfma_f32_16x16x32_bf16 v[216:219], v[172:175], v[32:35], v[216:219]
    v_and_or_b32 v66, v66, s66, v59
    v_and_or_b32 v67, v67, s66, v60
    v_mfma_f32_16x16x32_bf16 v[220:223], v[188:191], v[32:35], v[220:223]
    global_store_dwordx4 v17, v[64:67], s[34:35] offset:0 sc1
    s_nop 7
    v_cvt_pk_bf16_f32 v44, v208, v209
    v_cvt_pk_bf16_f32 v45, v210, v211
    v_cvt_pk_bf16_f32 v46, v212, v213
    v_cvt_pk_bf16_f32 v47, v214, v215
    v_cvt_pk_bf16_f32 v48, v216, v217
    v_cvt_pk_bf16_f32 v49, v218, v219
    v_cvt_pk_bf16_f32 v50, v220, v221
    v_cvt_pk_bf16_f32 v51, v222, v223
    v_cndmask_b32 v128, v44, v48, s[64:65]
    v_cndmask_b32 v129, v45, v49, s[64:65]
    v_cndmask_b32 v130, v46, v50, s[64:65]
    v_cndmask_b32 v131, v47, v51, s[64:65]
    v_and_or_b32 v128, v128, s66, v57
    v_and_or_b32 v129, v129, s66, v58
    v_and_or_b32 v130, v130, s66, v59
    v_and_or_b32 v131, v131, s66, v60
    global_store_dwordx4 v17, v[128:131], s[34:35] offset:128 sc1
    s_waitcnt vmcnt(2)
L_b_st2:
    s_barrier
    s_barrier
L_b_tail:
    s_barrier
    s_mov_b32 s52, s22
    s_mov_b32 s53, s23
    s_mov_b32 s54, 3456
    s_mov_b32 s55, 0x20000
    s_mov_b32 s56, s24
    s_mov_b32 s57, s25
    s_mov_b32 s58, 3456
    s_mov_b32 s59, 0x20000
    s_mov_b32 s60, s26
    s_mov_b32 s61, s27
    s_mov_b32 s62, 3456
    s_mov_b32 s63, 0x20000
    s_lshl_b32 s3, s4, 8
    v_lshl_add_u32 v4, v1, 2, s3
    buffer_load_dword v224, v4, s[52:55], 0 offen
    buffer_load_dword v225, v4, s[52:55], 0 offen offset:2048
    buffer_load_dword v226, v4, s[56:59], 0 offen
    buffer_load_dword v227, v4, s[56:59], 0 offen offset:2048
    buffer_load_dword v228, v4, s[60:63], 0 offen
    buffer_load_dword v229, v4, s[60:63], 0 offen offset:2048
    v_mov_b32 v4, 0
    global_load_ushort v231, v4, s[28:29]

    s_min_u32 s3, s4, 4
    s_lshl_b32 s3, s3, 8
    v_lshlrev_b32 v4, 4, v3
    v_and_b32 v230, 1, v2
    v_lshl_add_u32 v4, v230, 3, v4
    v_lshrrev_b32 v230, 1, v2
    v_lshl_add_u32 v4, v230, 2, v4
    v_add_u32 v4, s3, v4
    global_load_dword v230, v4, s[8:9]

    s_waitcnt vmcnt(0)
    v_lshlrev_b32 v232, 16, v224
    v_and_b32 v233, 0xffff0000, v224
    v_lshlrev_b32 v234, 16, v225
    v_and_b32 v235, 0xffff0000, v225
    v_lshlrev_b32 v236, 16, v226
    v_and_b32 v237, 0xffff0000, v226
    v_lshlrev_b32 v238, 16, v227
    v_and_b32 v239, 0xffff0000, v227
    v_lshlrev_b32 v240, 16, v228
    v_and_b32 v241, 0xffff0000, v228
    v_lshlrev_b32 v242, 16, v229
    v_and_b32 v243, 0xffff0000, v229
    v_mul_u32_u24 v244, 1280, v2
    v_lshl_add_u32 v244, v3, 4, v244
    s_lshl_b32 s3, s4, 8
    s_add_u32 s64, s3, 458752
    v_add_u32 v244, s64, v244
    v_add_u32 v245, 5120, v244
    s_lshl_b32 s3, s4, 9
    s_add_u32 s3, s3, 149632
    v_lshlrev_b32 v248, 5, v3
    v_and_b32 v57, 1, v2
    v_lshl_add_u32 v248, v57, 4, v248
    v_lshrrev_b32 v57, 1, v2
    v_lshl_add_u32 v248, v57, 3, v248
    v_add_u32 v248, s3, v248
    v_lshlrev_b32 v58, 16, v230
    v_and_b32 v59, 0xffff0000, v230
    v_mov_b32 v60, 0x3acccccd
    v_mov_b32 v61, 0x3f800054
    v_mov_b32 v65, 0x2edbe6ff
    v_mov_b32 v64, 0xc0135761
    v_mov_b32 v66, 0xbdd2d3e8
    v_mov_b32 v62, 152192
    s_lshr_b32 s101, s2, 3
    s_mul_i32 s101, s101, 3
    s_mul_i32 s3, s5, 80
    s_add_u32 s101, s101, s3
    s_lshl_b32 s3, s101, 2
    s_add_u32 s3, s3, 149632
    v_mov_b32 v63, s3
    s_lshl_b32 s3, s4, 3
    s_add_u32 s3, s3, 152192
    v_mov_b32 v68, s3
    s_lshl_b32 s3, s4, 4
    s_add_u32 s3, s3, 152256
    v_mov_b32 v69, s3
    v_mov_b32 v113, 0
    v_add_u32 v8, s101, v1
    v_lshlrev_b32 v6, 2, v1
    v_add_u32 v6, 152256, v6
    v_lshlrev_b32 v7, 2, v8
    v_add_u32 v7, 149632, v7
    v_lshlrev_b32 v9, 16, v231

    v_and_b32 v57, 3, v1
    v_lshlrev_b32 v14, 3, v57
    v_mov_b32 v15, s36
    v_lshrrev_b32 v14, v14, v15
    v_bfe_u32 v10, v14, 0, 1
    v_bfe_u32 v15, v14, 1, 1
    v_lshl_or_b32 v10, v15, 16, v10
    v_bfe_u32 v11, v14, 2, 1
    v_bfe_u32 v15, v14, 3, 1
    v_lshl_or_b32 v11, v15, 16, v11
    v_bfe_u32 v12, v14, 4, 1
    v_bfe_u32 v15, v14, 5, 1
    v_lshl_or_b32 v12, v15, 16, v12
    v_bfe_u32 v13, v14, 6, 1
    v_bfe_u32 v15, v14, 7, 1
    v_lshl_or_b32 v13, v15, 16, v13
    s_sleep 40
L_S7:
    s_cmp_lt_u32 s4, 5
    s_cbranch_scc0 L_s7_bar
    s_mov_b32 s66, 0x00010001
L_h5:
    global_load_dwordx4 v[40:43], v244, s[34:35] sc1
    global_load_dwordx4 v[44:47], v245, s[34:35] sc1
    s_waitcnt vmcnt(0)

    v_xor_b32 v40, v40, v10
    v_xor_b32 v41, v41, v11
    v_xor_b32 v42, v42, v12
    v_xor_b32 v43, v43, v13
    v_xor_b32 v44, v44, v10
    v_xor_b32 v45, v45, v11
    v_xor_b32 v46, v46, v12
    v_xor_b32 v47, v47, v13
    v_or3_b32 v56, v40, v41, v42
    v_or3_b32 v57, v43, v44, v45
    v_or3_b32 v56, v46, v47, v56
    v_or_b32 v56, v56, v57
    v_and_b32 v56, s66, v56
    v_cmp_ne_u32 vcc, 0, v56
    s_cbranch_vccz L_h5_done
    s_sub_u32 s100, s100, 1
    s_cbranch_scc0 L_h5
    s_branch L_fail
L_h5_done:
    s_or_b32 s3, s2, s4
    s_cmp_eq_u32 s3, 0
    s_cbranch_scc0 L_h5_noep
    v_lshlrev_b32 v48, 2, v1
    v_mov_b32 v49, s36
    s_mov_b64 exec, 0xffff
    global_store_dword v48, v49, s[34:35] sc1
    s_mov_b64 exec, -1

L_h5_noep:
    v_lshlrev_b32 v80, 16, v40
    v_and_b32 v81, 0xffff0000, v40
    v_lshlrev_b32 v82, 16, v41
    v_and_b32 v83, 0xffff0000, v41
    v_lshlrev_b32 v84, 16, v42
    v_and_b32 v85, 0xffff0000, v42
    v_lshlrev_b32 v86, 16, v43
    v_and_b32 v87, 0xffff0000, v43
    v_lshlrev_b32 v88, 16, v44
    v_and_b32 v89, 0xffff0000, v44
    v_pk_add_f32 v[80:81], v[80:81], v[88:89]
    v_lshlrev_b32 v90, 16, v45
    v_and_b32 v91, 0xffff0000, v45
    v_pk_add_f32 v[82:83], v[82:83], v[90:91]
    v_lshlrev_b32 v92, 16, v46
    v_and_b32 v93, 0xffff0000, v46
    v_pk_add_f32 v[84:85], v[84:85], v[92:93]
    v_lshlrev_b32 v94, 16, v47
    v_and_b32 v95, 0xffff0000, v47
    v_pk_add_f32 v[86:87], v[86:87], v[94:95]
    s_nop 0
    v_permlane16_swap_b32 v80, v84
    v_permlane16_swap_b32 v81, v85
    v_permlane16_swap_b32 v82, v86
    v_permlane16_swap_b32 v83, v87
    v_add_f32 v80, v80, v84
    v_add_f32 v81, v81, v85
    v_add_f32 v82, v82, v86
    v_add_f32 v83, v83, v87
    s_nop 0
    v_permlane32_swap_b32 v80, v82
    v_permlane32_swap_b32 v81, v83
    v_add_f32 v50, v80, v82
    v_add_f32 v51, v81, v83
    v_pk_add_f32 v[50:51], v[50:51], v[58:59]
    ds_write_b64 v248, v[50:51]
    v_add_f32 v52, v50, v51
    v_mul_f32 v53, v50, v50
    v_fmac_f32 v53, v51, v51

    s_nop 1
    v_add_f32_dpp v52, v52, v52 row_shr:1 row_mask:0xf bank_mask:0xf bound_ctrl:0
    v_add_f32_dpp v53, v53, v53 row_shr:1 row_mask:0xf bank_mask:0xf bound_ctrl:0
    s_nop 0
    v_add_f32_dpp v52, v52, v52 row_shr:2 row_mask:0xf bank_mask:0xf bound_ctrl:0
    v_add_f32_dpp v53, v53, v53 row_shr:2 row_mask:0xf bank_mask:0xf bound_ctrl:0
    s_nop 0
    v_add_f32_dpp v52, v52, v52 row_shr:4 row_mask:0xf bank_mask:0xf bound_ctrl:0
    v_add_f32_dpp v53, v53, v53 row_shr:4 row_mask:0xf bank_mask:0xf bound_ctrl:0
    s_nop 0
    v_add_f32_dpp v52, v52, v52 row_shr:8 row_mask:0xf bank_mask:0xf bound_ctrl:0
    v_add_f32_dpp v53, v53, v53 row_shr:8 row_mask:0xf bank_mask:0xf bound_ctrl:0
    s_nop 0
    v_add_f32_dpp v52, v52, v52 row_bcast:15 row_mask:0xa bank_mask:0xf
    v_add_f32_dpp v53, v53, v53 row_bcast:15 row_mask:0xa bank_mask:0xf
    s_nop 0
    v_add_f32_dpp v52, v52, v52 row_bcast:31 row_mask:0xc bank_mask:0xf
    v_add_f32_dpp v53, v53, v53 row_bcast:31 row_mask:0xc bank_mask:0xf
    s_mov_b32 exec_lo, 0
    s_mov_b32 exec_hi, 0x80000000
    ds_write_b64 v68, v[52:53]
    s_mov_b64 exec, -1

L_s7_bar:
    s_waitcnt lgkmcnt(0)
    s_barrier

    s_cmp_lt_u32 s2, 216
    s_cbranch_scc0 L_fin

L_s7_body:
    ds_read_b128 v[40:43], v62
    ds_read_b128 v[44:47], v62 offset:16
    ds_read_b64 v[48:49], v62 offset:32
    ds_read_b32 v50, v63
    ds_read_b32 v52, v63 offset:4
    ds_read_b32 v54, v63 offset:8
    s_waitcnt lgkmcnt(3)
    v_pk_add_f32 v[40:41], v[40:41], v[42:43]
    v_pk_add_f32 v[44:45], v[44:45], v[46:47]
    v_pk_add_f32 v[40:41], v[40:41], v[48:49]
    v_pk_add_f32 v[40:41], v[40:41], v[44:45]
    v_pk_mul_f32 v[40:41], v[40:41], v[60:61] op_sel_hi:[1,0]
    v_fma_f32 v41, -v40, v40, v41
    v_max_f32 v41, 0, v41
    v_fma_f32 v42, v41, v61, v65
    s_waitcnt lgkmcnt(0)
    v_rsq_f32 v42, v42
    v_sub_f32 v70, v50, v40
    v_sub_f32 v72, v52, v40
    v_sub_f32 v74, v54, v40
    v_mul_f32 v70, v70, v42
    v_mul_f32 v72, v72, v42
    v_mul_f32 v74, v74, v42

    v_pk_fma_f32 v[80:81], v[70:71], v[232:233], v[236:237] op_sel_hi:[0,1,1]
    v_pk_fma_f32 v[82:83], v[70:71], v[234:235], v[238:239] op_sel_hi:[0,1,1]
    v_pk_fma_f32 v[84:85], v[72:73], v[232:233], v[236:237] op_sel_hi:[0,1,1]
    v_pk_fma_f32 v[86:87], v[72:73], v[234:235], v[238:239] op_sel_hi:[0,1,1]
    v_pk_fma_f32 v[88:89], v[74:75], v[232:233], v[236:237] op_sel_hi:[0,1,1]
    v_pk_fma_f32 v[90:91], v[74:75], v[234:235], v[238:239] op_sel_hi:[0,1,1]
    v_pk_mul_f32 v[92:93], v[80:81], v[80:81]
    v_pk_mul_f32 v[94:95], v[82:83], v[82:83]
    v_pk_mul_f32 v[96:97], v[84:85], v[84:85]
    v_pk_mul_f32 v[98:99], v[86:87], v[86:87]
    v_pk_mul_f32 v[100:101], v[88:89], v[88:89]
    v_pk_mul_f32 v[102:103], v[90:91], v[90:91]
    v_pk_fma_f32 v[92:93], v[92:93], v[66:67], v[64:65] op_sel_hi:[1,0,0]
    v_pk_fma_f32 v[94:95], v[94:95], v[66:67], v[64:65] op_sel_hi:[1,0,0]
    v_pk_fma_f32 v[96:97], v[96:97], v[66:67], v[64:65] op_sel_hi:[1,0,0]
    v_pk_fma_f32 v[98:99], v[98:99], v[66:67], v[64:65] op_sel_hi:[1,0,0]
    v_pk_fma_f32 v[100:101], v[100:101], v[66:67], v[64:65] op_sel_hi:[1,0,0]
    v_pk_fma_f32 v[102:103], v[102:103], v[66:67], v[64:65] op_sel_hi:[1,0,0]
    v_pk_mul_f32 v[92:93], v[92:93], v[80:81]
    v_pk_mul_f32 v[94:95], v[94:95], v[82:83]
    v_pk_mul_f32 v[96:97], v[96:97], v[84:85]
    v_pk_mul_f32 v[98:99], v[98:99], v[86:87]
    v_pk_mul_f32 v[100:101], v[100:101], v[88:89]
    v_pk_mul_f32 v[102:103], v[102:103], v[90:91]
    v_exp_f32 v92, v92
    v_exp_f32 v93, v93
    v_exp_f32 v94, v94
    v_exp_f32 v95, v95
    v_exp_f32 v96, v96
    v_exp_f32 v97, v97
    v_exp_f32 v98, v98
    v_exp_f32 v99, v99
    v_exp_f32 v100, v100
    v_exp_f32 v101, v101
    v_exp_f32 v102, v102
    v_exp_f32 v103, v103
    v_pk_add_f32 v[92:93], v[92:93], 1.0 op_sel_hi:[1,0]
    v_pk_add_f32 v[94:95], v[94:95], 1.0 op_sel_hi:[1,0]
    v_pk_add_f32 v[96:97], v[96:97], 1.0 op_sel_hi:[1,0]
    v_pk_add_f32 v[98:99], v[98:99], 1.0 op_sel_hi:[1,0]
    v_pk_add_f32 v[100:101], v[100:101], 1.0 op_sel_hi:[1,0]
    v_pk_add_f32 v[102:103], v[102:103], 1.0 op_sel_hi:[1,0]
    v_rcp_f32 v92, v92
    v_rcp_f32 v93, v93
    v_rcp_f32 v94, v94
    v_rcp_f32 v95, v95
    v_rcp_f32 v96, v96
    v_rcp_f32 v97, v97
    v_rcp_f32 v98, v98
    v_rcp_f32 v99, v99
    v_rcp_f32 v100, v100
    v_rcp_f32 v101, v101
    v_rcp_f32 v102, v102
    v_rcp_f32 v103, v103
    v_pk_mul_f32 v[80:81], v[80:81], v[92:93]
    v_pk_mul_f32 v[82:83], v[82:83], v[94:95]
    v_pk_mul_f32 v[84:85], v[84:85], v[96:97]
    v_pk_mul_f32 v[86:87], v[86:87], v[98:99]
    v_pk_mul_f32 v[88:89], v[88:89], v[100:101]
    v_pk_mul_f32 v[90:91], v[90:91], v[102:103]
    v_pk_mul_f32 v[104:105], v[80:81], v[240:241]
    v_pk_mul_f32 v[106:107], v[84:85], v[240:241]
    v_pk_mul_f32 v[108:109], v[88:89], v[240:241]
    v_pk_fma_f32 v[104:105], v[82:83], v[242:243], v[104:105]
    v_pk_fma_f32 v[106:107], v[86:87], v[242:243], v[106:107]
    v_pk_fma_f32 v[108:109], v[90:91], v[242:243], v[108:109]
    v_add_f32 v110, v104, v105
    v_add_f32 v111, v106, v107
    v_add_f32 v112, v108, v109
    s_nop 1
    v_add_f32_dpp v110, v110, v110 row_shr:1 row_mask:0xf bank_mask:0xf bound_ctrl:0
    v_add_f32_dpp v111, v111, v111 row_shr:1 row_mask:0xf bank_mask:0xf bound_ctrl:0
    v_add_f32_dpp v112, v112, v112 row_shr:1 row_mask:0xf bank_mask:0xf bound_ctrl:0
    v_add_f32_dpp v110, v110, v110 row_shr:2 row_mask:0xf bank_mask:0xf bound_ctrl:0
    v_add_f32_dpp v111, v111, v111 row_shr:2 row_mask:0xf bank_mask:0xf bound_ctrl:0
    v_add_f32_dpp v112, v112, v112 row_shr:2 row_mask:0xf bank_mask:0xf bound_ctrl:0
    v_add_f32_dpp v110, v110, v110 row_shr:4 row_mask:0xf bank_mask:0xf bound_ctrl:0
    v_add_f32_dpp v111, v111, v111 row_shr:4 row_mask:0xf bank_mask:0xf bound_ctrl:0
    v_add_f32_dpp v112, v112, v112 row_shr:4 row_mask:0xf bank_mask:0xf bound_ctrl:0
    v_add_f32_dpp v110, v110, v110 row_shr:8 row_mask:0xf bank_mask:0xf bound_ctrl:0
    v_add_f32_dpp v111, v111, v111 row_shr:8 row_mask:0xf bank_mask:0xf bound_ctrl:0
    v_add_f32_dpp v112, v112, v112 row_shr:8 row_mask:0xf bank_mask:0xf bound_ctrl:0
    v_add_f32_dpp v110, v110, v110 row_bcast:15 row_mask:0xa bank_mask:0xf
    v_add_f32_dpp v111, v111, v111 row_bcast:15 row_mask:0xa bank_mask:0xf
    v_add_f32_dpp v112, v112, v112 row_bcast:15 row_mask:0xa bank_mask:0xf
    v_add_f32_dpp v110, v110, v110 row_bcast:31 row_mask:0xc bank_mask:0xf
    v_add_f32_dpp v111, v111, v111 row_bcast:31 row_mask:0xc bank_mask:0xf
    v_add_f32_dpp v112, v112, v112 row_bcast:31 row_mask:0xc bank_mask:0xf
    s_mov_b32 exec_lo, 0
    s_mov_b32 exec_hi, 0x80000000
    ds_write_b128 v69, v[110:113]
    s_mov_b64 exec, -1

    s_mul_i32 s3, s5, 80
    s_add_u32 s3, s3, 80
    v_cmp_gt_u32 vcc, s3, v8
    v_lshlrev_b32 v8, 1, v8
    s_waitcnt lgkmcnt(0)
    s_barrier

    s_cmp_eq_u32 s4, 0
    s_cbranch_scc0 L_fin
    s_and_b64 vcc, vcc, 7
    s_and_saveexec_b64 s[64:65], vcc
    s_cbranch_execz L_fin0

    ds_read_b32 v40, v6 offset:0
    ds_read_b32 v41, v6 offset:16
    ds_read_b32 v42, v6 offset:32
    ds_read_b32 v43, v6 offset:48
    ds_read_b32 v44, v6 offset:64
    ds_read_b32 v45, v6 offset:80
    ds_read_b32 v46, v6 offset:96
    ds_read_b32 v47, v6 offset:112
    ds_read_b32 v48, v7
    s_waitcnt lgkmcnt(0)
    v_add_f32 v40, v40, v41
    v_add_f32 v42, v42, v43
    v_add_f32 v44, v44, v45
    v_add_f32 v46, v46, v47
    v_add_f32 v48, v48, v9
    v_add_f32 v40, v40, v42
    v_add_f32 v44, v44, v46
    v_add_f32 v40, v40, v48
    v_add_f32 v40, v40, v44
    v_cvt_pk_bf16_f32 v40, v40, v40
    global_store_short v8, v40, s[30:31]

L_fin0:
    s_mov_b64 exec, s[64:65]
L_fin:
    s_cmp_eq_u32 s2, 100000
    s_cbranch_scc0 L_noepoch
    s_cmp_eq_u32 s4, 0
    s_cbranch_scc0 L_noepoch
    v_lshlrev_b32 v6, 2, v1
    v_mov_b32 v7, s36
    s_mov_b64 exec, 0xffff
    global_store_dword v6, v7, s[34:35] sc1
    s_mov_b64 exec, -1

L_noepoch:
L_exit:
    s_endpgm
L_fail:
    s_endpgm
L_end:
.section .rodata,"a"
.p2align 6
.amdhsa_kernel sequential_preLN__compressed_kv_cla__mixer_token_mlp__decode_kernel
  .amdhsa_next_free_vgpr 256
  .amdhsa_next_free_sgpr 102
  .amdhsa_accum_offset 256
  .amdhsa_group_segment_fixed_size 0
  .amdhsa_kernarg_size 112
  .amdhsa_user_sgpr_count 2
  .amdhsa_user_sgpr_kernarg_segment_ptr 1
  .amdhsa_system_sgpr_workgroup_id_x 1
.end_amdhsa_kernel
```
